```python
import torch

def _softmax(x, axis=-1):
    return torch.softmax(x, dim=axis)
def _gelu(x):
    return torch.nn.functional.gelu(x, approximate="tanh")
def _silu(x):
    return torch.nn.functional.silu(x)
def _sigmoid(x):
    return torch.sigmoid(x)
def _layernorm(x, axis=-1, eps=1e-5):
    m = x.mean(dim=axis, keepdim=True)
    v = x.var(dim=axis, keepdim=True, unbiased=False)
    return (x - m) / torch.sqrt(v + eps)
def _scatter_add(tgt, idx, src, axis=0):
    return tgt.clone().index_add_(axis, idx, src)
def _segment_sum(src, seg, n):
    out = torch.zeros((n,) + src.shape[1:], dtype=src.dtype)
    return out.index_add_(0, seg, src)
def _pad(x, pw):
    flat = tuple(v for pair in reversed(pw) for v in pair)
    return torch.nn.functional.pad(x, flat)

kernel_name = 'sequential_preLN__ssm_conv_s4d__swiglu_ffn__prompt'

def setup_inputs():

    _w = (lambda a: (lambda t: t.to(torch.bfloat16) if t.is_floating_point() else t)(torch.as_tensor(a)))
    def _A_setup():
        Bsz, L, D, N = 1, 2048, 640, 192
        return {
            "u": _w((lambda *s: torch.randn(*s, dtype=torch.bfloat16) * 0.05)(Bsz, L, D)),
            "log_A_real": _w((lambda *s: torch.randn(*s, dtype=torch.bfloat16) * 6.4)(D, N) * 0.5),
            "A_imag": _w((lambda *s: torch.randn(*s, dtype=torch.bfloat16) * 0.05)(D, N) * 3.14),
            "C_real": _w((lambda *s: torch.randn(*s, dtype=torch.bfloat16) * 0.05)(D, N) / N ** 0.5),
            "C_imag": _w((lambda *s: torch.randn(*s, dtype=torch.bfloat16) * 0.05)(D, N) / N ** 0.5),
            "log_dt": _w((lambda *s: torch.randn(*s, dtype=torch.bfloat16) * 0.05)(D) * 0.5 - 4.0),
            "D_skip": _w((lambda *s: torch.randn(*s, dtype=torch.bfloat16) * 0.05)(D)),
        }
    _A_in = _A_setup()

    def _B_setup():
        B, S, D, F = 1, 2048, 640, 1536
        return {
            "x": _w((lambda *s: torch.randn(*s, dtype=torch.bfloat16) * 0.05)(B, S, D)),
            "w_gate": _w((lambda *s: torch.randn(*s, dtype=torch.bfloat16) * 0.05)(D, F)),
            "w_up": _w((lambda *s: torch.randn(*s, dtype=torch.bfloat16) * 0.05)(D, F)),
            "w_down": _w((lambda *s: torch.randn(*s, dtype=torch.bfloat16) * 0.05)(F, D)),
        }
    _B_in = _B_setup()

    return {
        "A_u": _A_in["u"],
        "A_log_A_real": _A_in["log_A_real"],
        "A_A_imag": _A_in["A_imag"],
        "A_C_real": _A_in["C_real"],
        "A_C_imag": _A_in["C_imag"],
        "A_log_dt": _A_in["log_dt"],
        "A_D_skip": _A_in["D_skip"],
        "B_x": _B_in["x"],
        "B_w_gate": _B_in["w_gate"],
        "B_w_up": _B_in["w_up"],
        "B_w_down": _B_in["w_down"],
    }

def reference(A_u, A_log_A_real, A_A_imag, A_C_real, A_C_imag, A_log_dt, A_D_skip, B_x, B_w_gate, B_w_up, B_w_down):
    def _A_ref(u, log_A_real, A_imag, C_real, C_imag, log_dt, D_skip):
        L = u.shape[1]
        dt = torch.exp(log_dt)
        A = -torch.exp(log_A_real) + 1j * A_imag
        C = (C_real + 1j * C_imag) * dt[:, None]
        pos = (lambda x, dt: x.to(dt))(torch.arange(L), log_dt.dtype)
        P = torch.exp((A * dt[:, None])[:, :, None] * pos[None, None, :])
        K = 2.0 * torch.einsum("dn,dnl->dl", C, P).real
        L2 = 2 * L
        u_t = (lambda x, *d: x.permute(*d))(u, 0, 2, 1)
        Kf = (lambda x, *a, **k: torch.fft.rfft(x.float(), *a, **k))(K, L2)
        Uf = (lambda x, *a, **k: torch.fft.rfft(x.float(), *a, **k))(u_t, L2)
        y = (lambda x, *a, **k: torch.fft.irfft(x, *a, **k).to(torch.bfloat16))(Uf * Kf[None, :, :], L2)[:, :, :L]
        y = (lambda x, *d: x.permute(*d))(y, 0, 2, 1)
        return y + u * D_skip[None, None, :]

    def _B_ref(x, w_gate, w_up, w_down):
        g = _silu(x @ w_gate)
        u = x @ w_up
        return (g * u) @ w_down

    x = A_u
    h = x + _A_ref(_layernorm(x, axis=-1), A_log_A_real, A_A_imag, A_C_real, A_C_imag, A_log_dt, A_D_skip)
    h2 = h + _B_ref(_layernorm(h, axis=-1), B_w_gate, B_w_up, B_w_down)
    return h2
```

```asm
; @launch kernel=front_kernel grid=(256,1,1) block=(768,1,1) lds=163840
; @launch kernel=ffn_kernel grid=(256,1,1) block=(512,1,1) lds=163840
.amdgcn_target "amdgcn-amd-amdhsa--gfx950"
.text

.globl front_kernel
.p2align 8
.type front_kernel,@function
front_kernel:
    s_cmp_ge_u32 s2, 256
    s_cbranch_scc1 k12_end
    s_cmp_ge_u32 s2, 8
    s_cbranch_scc1 k12_nocode
    s_getpc_b64 s[40:41]
k12_pc0:
    s_sub_u32 s40, s40, k12_pc0-front_kernel
    s_subb_u32 s41, s41, 0
    s_mov_b32 s42, code_end-front_kernel
    s_mov_b32 s43, 0x20000
    v_lshlrev_b32 v166, 7, v0
    buffer_load_dword v167, v166, s[40:43], 0 offen
k12_nocode:
    s_load_dwordx8 s[4:11], s[0:1], 0
    s_load_dwordx4 s[12:15], s[0:1], 32
    s_load_dwordx2 s[16:17], s[0:1], 104
    s_load_dwordx2 s[62:63], s[0:1], 48
    v_lshrrev_b32 v1, 6, v0
    v_and_b32 v0, 63, v0
    v_readfirstlane_b32 s20, v1
    s_and_b32 s23, s2, 7
    s_mul_i32 s21, s23, 80
    s_lshr_b32 s23, s2, 4
    s_mul_i32 s23, s23, 5
    s_add_u32 s21, s21, s23
    s_bfe_u32 s23, s2, 0x10003
    s_sub_u32 s22, 3, s23
    s_mul_i32 s23, s23, 3
    s_add_u32 s21, s21, s23
    s_mov_b32 s48, 0xffff0000
    s_mov_b32 s69, 0
    s_lshr_b32 s19, s2, 3
    s_and_b32 s59, s19, 1
    s_and_b32 s18, s2, 7
    s_lshl_b32 s18, s18, 5
    s_add_u32 s18, s18, s19
    s_lshl_b32 s49, s20, 2
    s_mov_b32 s60, 0x85437210
    s_lshr_b32 s60, s60, s49
    s_and_b32 s60, s60, 15
    s_cmp_ge_u32 s20, 8
    s_cselect_b32 s60, 15, s60
    s_cmp_eq_u32 s20, 10
    s_cselect_b32 s60, 6, s60
    s_mul_i32 s49, s22, 3
    s_cmp_lt_u32 s60, s49
    s_cselect_b32 s61, 1, 0
    s_mul_i32 s56, s60, 43
    s_lshr_b32 s56, s56, 7
    s_mul_i32 s49, s56, 3
    s_sub_u32 s57, s60, s49
    s_add_u32 s37, s21, s56
    s_mul_i32 s36, s37, 384
    s_lshl_b32 s49, s57, 7
    s_add_u32 s58, s36, s49
    s_mul_i32 s55, s60, 8704
    s_add_u32 s55, s55, 65376
    s_cmp_ge_u32 s20, 10
    s_cbranch_scc1 k12_late
    v_lshrrev_b32 v2, 3, v0
    v_and_b32 v3, 7, v0
    v_mul_u32_u24 v1, 1280, v2
    v_lshl_add_u32 v1, v3, 4, v1
    s_mul_i32 s23, s18, 10240
    s_lshl_b32 s49, s20, 7
    s_add_u32 s23, s23, s49
    v_lshlrev_b32 v4, 1, v0
    s_waitcnt lgkmcnt(0)
    s_mov_b32 s24, s4
    s_mov_b32 s25, s5
    s_mov_b32 s26, 2621440
    s_mov_b32 s27, 0x20000
    buffer_load_dwordx4 v[16:19], v1, s[24:27], s23 offen nt
    s_add_u32 s24, s16, 19791872
    s_addc_u32 s25, s17, 0
    s_mov_b32 s26, 4
    s_mov_b32 s27, 0x20000
    buffer_load_dword v160, off, s[24:27], 0
    s_cmp_eq_u32 s61, 0
    s_cbranch_scc1 k12_nopar
    s_mov_b32 s28, s6
    s_mov_b32 s29, s7
    s_mov_b32 s30, 245760
    s_mov_b32 s31, 0x20000
    s_mov_b32 s32, s8
    s_mov_b32 s33, s9
    s_mov_b32 s34, 245760
    s_mov_b32 s35, 0x20000
    s_mov_b32 s40, s10
    s_mov_b32 s41, s11
    s_mov_b32 s42, 245760
    s_mov_b32 s43, 0x20000
    s_mov_b32 s44, s12
    s_mov_b32 s45, s13
    s_mov_b32 s46, 245760
    s_mov_b32 s47, 0x20000
    buffer_load_ushort v152, v4, s[40:43], s36 offen offset:0 nt
    buffer_load_ushort v153, v4, s[44:47], s36 offen offset:0 nt
    buffer_load_ushort v154, v4, s[40:43], s36 offen offset:128 nt
    buffer_load_ushort v155, v4, s[44:47], s36 offen offset:128 nt
    buffer_load_ushort v156, v4, s[40:43], s36 offen offset:256 nt
    buffer_load_ushort v157, v4, s[44:47], s36 offen offset:256 nt
    buffer_load_ushort v148, v4, s[28:31], s58 offen nt
    buffer_load_ushort v149, v4, s[32:35], s58 offen nt
    buffer_load_ushort v150, v4, s[40:43], s58 offen nt
    buffer_load_ushort v151, v4, s[44:47], s58 offen nt
    s_lshr_b32 s49, s37, 1
    s_lshl_b32 s49, s49, 2
    s_load_dword s60, s[14:15], s49
k12_nopar:
    s_lshr_b32 s50, s20, 2
    s_and_b32 s51, s20, 3
    v_and_b32 v5, 15, v0
    v_lshrrev_b32 v6, 4, v0
    v_and_b32 v7, 1, v6
    v_lshrrev_b32 v8, 1, v6
    v_lshl_add_u32 v7, v7, 1, v8
    v_lshl_add_u32 v165, v5, 2, v7
    s_mul_i32 s52, s50, 16640
    s_add_u32 s52, s52, 15456
    s_mul_i32 s53, s50, 5152
    s_lshl_b32 s49, s51, 10
    s_add_u32 s49, s49, s52
    v_lshl_add_u32 v161, v0, 4, s49
    v_mul_u32_u24 v162, 1280, v7
    v_lshl_add_u32 v162, v5, 4, v162
    s_lshl_b32 s49, s51, 8
    s_add_u32 s49, s49, s53
    v_add_u32 v162, s49, v162
    v_mul_u32_u24 v164, 1280, v6
    v_lshl_add_u32 v164, v5, 4, v164
    s_lshl_b32 s49, s51, 6
    s_sub_u32 s49, s53, s49
    s_add_u32 s49, s49, 192
    v_add_u32 v164, s49, v164
    v_bfe_u32 v7, v0, 2, 2
    v_mul_u32_u24 v7, 4160, v7
    v_and_b32 v8, 3, v0
    v_lshl_add_u32 v163, v8, 3, v7
    v_lshlrev_b32 v7, 4, v6
    v_sub_u32 v163, v163, v7
    s_lshl_b32 s49, s51, 8
    s_add_u32 s49, s49, s52
    s_add_u32 s49, s49, 56
    v_add_u32 v163, s49, v163
    s_setprio 2
    s_barrier
    s_mov_b32 s24, s16
    s_mov_b32 s25, s17
    s_mov_b32 s26, 5242880
    s_mov_b32 s27, 0x20000
    s_mul_i32 s49, s20, 3072
    s_add_u32 s49, s49, 119136
    s_cmp_ge_u32 s20, 8
    s_cselect_b32 s34, s49, s55
    v_mul_u32_u24 v12, 192, v2
    v_lshl_add_u32 v12, v3, 4, v12
    v_add_u32 v12, s34, v12
    v_bfe_u32 v5, v0, 2, 2
    v_mul_u32_u24 v13, 192, v5
    v_lshrrev_b32 v5, 4, v0
    v_lshl_add_u32 v13, v5, 5, v13
    v_and_b32 v5, 3, v0
    v_lshl_add_u32 v13, v5, 3, v13
    v_add_u32 v13, s34, v13
    s_lshl_b32 s49, s20, 6
    v_lshl_add_u32 v9, v2, 3, s49
    v_lshlrev_b32 v11, 6, v3
    v_lshl_add_u32 v11, v2, 3, v11
    v_and_b32 v5, 1, v0
    v_lshlrev_b32 v5, 6, v5
    v_lshl_add_u32 v5, v2, 3, v5
    v_lshlrev_b32 v1, 4, v0
    s_mul_i32 s23, s18, 10240
    s_lshl_b32 s49, s20, 10
    s_add_u32 s23, s23, s49
    s_add_u32 s35, s23, 2621440
    s_mov_b32 s50, 0x3f803f80
    s_mov_b32 s51, 0x00003f80
    s_mov_b32 s52, 0x3f800000
    s_cmp_eq_u32 s61, 0
    s_waitcnt vmcnt(11)
    s_cbranch_scc0 k12_xin
    s_waitcnt vmcnt(1)
k12_xin:
    v_dot2_f32_bf16 v6, v16, s50, 0
    v_dot2_f32_bf16 v7, v16, v16, 0
    v_dot2_f32_bf16 v6, v17, s50, v6
    v_dot2_f32_bf16 v7, v17, v17, v7
    v_dot2_f32_bf16 v6, v18, s50, v6
    v_dot2_f32_bf16 v7, v18, v18, v7
    v_dot2_f32_bf16 v6, v19, s50, v6
    v_dot2_f32_bf16 v7, v19, v19, v7
    ds_write_b128 v12, v[16:19]
    s_nop 0
    v_add_f32_dpp v6, v6, v6 quad_perm:[1,0,3,2] row_mask:0xf bank_mask:0xf
    v_add_f32_dpp v7, v7, v7 quad_perm:[1,0,3,2] row_mask:0xf bank_mask:0xf
    s_nop 0
    v_add_f32_dpp v6, v6, v6 quad_perm:[2,3,0,1] row_mask:0xf bank_mask:0xf
    v_add_f32_dpp v7, v7, v7 quad_perm:[2,3,0,1] row_mask:0xf bank_mask:0xf
    s_nop 0
    v_add_f32_dpp v6, v6, v6 row_half_mirror row_mask:0xf bank_mask:0xf
    v_add_f32_dpp v7, v7, v7 row_half_mirror row_mask:0xf bank_mask:0xf
    ds_write_b64 v9, v[6:7]
    v_mov_b32 v14, 163680
    v_mov_b32 v15, 1
    s_mov_b64 exec, 1
    ds_add_u32 v14, v15
    s_mov_b64 exec, -1
    ds_read_b64_tr_b16 v[36:37], v13 offset:0
    ds_read_b64_tr_b16 v[38:39], v13 offset:768
    v_cmp_gt_u32 vcc, 2, v3
    s_waitcnt lgkmcnt(0)
    buffer_store_dwordx4 v[36:39], v1, s[24:27], s35 offen sc1
    v_mov_b32 v14, 163680
    s_mov_b32 s68, 0x40000
k12_s0:
    s_sub_u32 s68, s68, 1
    s_cbranch_scc1 k12_s0_x
    ds_read_b32 v15, v14
    s_waitcnt lgkmcnt(0)
    v_readfirstlane_b32 s49, v15
    s_nop 0
    s_cmp_lt_u32 s49, 10
    s_cbranch_scc1 k12_s0
k12_s0_x:
    ds_read_b64 v[6:7], v11
    ds_read_b64 v[20:21], v5 offset:512
    s_waitcnt lgkmcnt(0)
    v_cndmask_b32 v20, 0, v20, vcc
    v_cndmask_b32 v21, 0, v21, vcc
    v_add_f32 v6, v6, v20
    v_add_f32 v7, v7, v21
    s_nop 0
    v_add_f32_dpp v6, v6, v6 quad_perm:[1,0,3,2] row_mask:0xf bank_mask:0xf
    v_add_f32_dpp v7, v7, v7 quad_perm:[1,0,3,2] row_mask:0xf bank_mask:0xf
    s_nop 0
    v_add_f32_dpp v6, v6, v6 quad_perm:[2,3,0,1] row_mask:0xf bank_mask:0xf
    v_add_f32_dpp v7, v7, v7 quad_perm:[2,3,0,1] row_mask:0xf bank_mask:0xf
    s_nop 0
    v_add_f32_dpp v6, v6, v6 row_half_mirror row_mask:0xf bank_mask:0xf
    v_add_f32_dpp v7, v7, v7 row_half_mirror row_mask:0xf bank_mask:0xf
    v_mul_f32 v6, 0x3acccccd, v6
    v_mul_f32 v7, 0x3acccccd, v7
    v_fma_f32 v7, -v6, v6, v7
    v_cvt_pk_bf16_f32 v5, v6, v7
    v_lshlrev_b32 v8, 16, v5
    v_and_b32 v5, s48, v5
    v_add_f32 v5, 0x3727c5ac, v5
    v_cvt_pk_bf16_f32 v5, v5, v5
    v_and_b32 v5, s48, v5
    v_sqrt_f32 v5, v5
    s_nop 0
    v_cvt_pk_bf16_f32 v5, v5, v5
    v_and_b32 v5, s48, v5
    v_rcp_f32 v10, v5
    v_sub_f32 v8, 0, v8
    v_dot2_f32_bf16 v20, v16, s51, v8
    v_dot2_f32_bf16 v21, v16, s52, v8
    v_dot2_f32_bf16 v22, v17, s51, v8
    v_dot2_f32_bf16 v23, v17, s52, v8
    v_dot2_f32_bf16 v24, v18, s51, v8
    v_dot2_f32_bf16 v25, v18, s52, v8
    v_dot2_f32_bf16 v26, v19, s51, v8
    v_dot2_f32_bf16 v27, v19, s52, v8
    v_cvt_pk_bf16_f32 v28, v20, v21
    v_cvt_pk_bf16_f32 v29, v22, v23
    v_cvt_pk_bf16_f32 v30, v24, v25
    v_cvt_pk_bf16_f32 v31, v26, v27
    v_lshlrev_b32 v20, 16, v28
    v_and_b32 v21, s48, v28
    v_lshlrev_b32 v22, 16, v29
    v_and_b32 v23, s48, v29
    v_lshlrev_b32 v24, 16, v30
    v_and_b32 v25, s48, v30
    v_lshlrev_b32 v26, 16, v31
    v_and_b32 v27, s48, v31
    v_mul_f32 v20, v20, v10
    v_mul_f32 v21, v21, v10
    v_mul_f32 v22, v22, v10
    v_mul_f32 v23, v23, v10
    v_mul_f32 v24, v24, v10
    v_mul_f32 v25, v25, v10
    v_mul_f32 v26, v26, v10
    v_mul_f32 v27, v27, v10
    v_cvt_pk_bf16_f32 v28, v20, v21
    v_cvt_pk_bf16_f32 v29, v22, v23
    v_cvt_pk_bf16_f32 v30, v24, v25
    v_cvt_pk_bf16_f32 v31, v26, v27
    v_lshlrev_b32 v20, 16, v28
    v_and_b32 v21, s48, v28
    v_lshlrev_b32 v22, 16, v29
    v_and_b32 v23, s48, v29
    v_lshlrev_b32 v24, 16, v30
    v_and_b32 v25, s48, v30
    v_lshlrev_b32 v26, 16, v31
    v_and_b32 v27, s48, v31
    v_cvt_pk_f16_f32 v28, v20, v21
    v_cvt_pk_f16_f32 v29, v22, v23
    v_cvt_pk_f16_f32 v30, v24, v25
    v_cvt_pk_f16_f32 v31, v26, v27
    ds_write_b128 v12, v[28:31] offset:1536
    ds_read_b64_tr_b16 v[32:33], v13 offset:1536
    ds_read_b64_tr_b16 v[34:35], v13 offset:2304
    s_waitcnt lgkmcnt(0)
    buffer_store_dwordx4 v[32:35], v1, s[24:27], s23 offen sc1
    s_cmp_eq_u32 s61, 0
    s_cbranch_scc1 k12_aux
k12_gen:
    s_setprio 0
    s_waitcnt vmcnt(2)
    s_mov_b32 s50, 0x3fb8aa3b
    s_mov_b32 s51, 0x32a57060
    s_mov_b32 s52, 0x3f317218
    s_mov_b32 s53, 0x3e22f983
    s_mov_b32 s54, 0x31dc9c88
    v_lshl_add_u32 v2, v0, 2, s55
    v_and_b32 v7, 31, v0
    v_mul_u32_u24 v7, 272, v7
    v_lshrrev_b32 v8, 5, v0
    v_lshl_add_u32 v7, v8, 4, v7
    v_add_u32 v3, s55, v7
    s_and_b32 s49, s37, 1
    s_lshl_b32 s49, s49, 4
    s_lshr_b32 s60, s60, s49
    s_lshl_b32 s60, s60, 16
    v_mov_b32 v7, s60
    v_mul_f32 v8, s50, v7
    v_fma_f32 v9, v7, s50, -v8
    v_exp_f32 v8, v8
    v_fma_f32 v9, v7, s51, v9
    v_mul_f32 v9, s52, v9
    v_fma_f32 v8, v8, v9, v8
    v_cvt_pk_bf16_f32 v8, v8, v8
    v_lshlrev_b32 v4, 16, v8
    v_and_b32 v152, 0x7fff, v152
    v_and_b32 v153, 0x7fff, v153
    v_and_b32 v154, 0x7fff, v154
    v_and_b32 v155, 0x7fff, v155
    v_and_b32 v156, 0x7fff, v156
    v_and_b32 v157, 0x7fff, v157
    v_max3_u32 v7, v152, v153, v154
    v_max3_u32 v8, v155, v156, v157
    v_max_u32 v7, v7, v8
    v_lshlrev_b32 v148, 16, v148
    v_lshlrev_b32 v149, 16, v149
    v_lshlrev_b32 v150, 16, v150
    v_lshlrev_b32 v151, 16, v151
    v_lshlrev_b32 v7, 16, v7
    v_mul_f32 v11, s50, v148
    s_nop 0
    v_max_f32_dpp v7, v7, v7 quad_perm:[1,0,3,2] row_mask:0xf bank_mask:0xf
    v_fma_f32 v12, v148, s50, -v11
    v_exp_f32 v11, v11
    v_max_f32_dpp v7, v7, v7 quad_perm:[2,3,0,1] row_mask:0xf bank_mask:0xf
    v_fma_f32 v12, v148, s51, v12
    s_nop 0
    v_max_f32_dpp v7, v7, v7 row_half_mirror row_mask:0xf bank_mask:0xf
    v_mul_f32 v12, s52, v12
    v_fma_f32 v11, v11, v12, v11
    v_max_f32_dpp v7, v7, v7 row_mirror row_mask:0xf bank_mask:0xf
    v_cvt_pk_bf16_f32 v11, v11, v11
    v_lshlrev_b32 v10, 16, v11
    v_mov_b32 v8, v7
    v_mul_f32 v10, v10, v4
    v_mul_f32 v30, 0xbfb8aa3b, v10
    v_permlane16_swap_b32 v7, v8
    v_mul_f32 v10, v149, v4
    v_mul_f32 v31, s53, v10
    v_max_f32 v7, v7, v8
    v_fma_f32 v32, v10, s53, -v31
    v_mov_b32 v8, v7
    v_fma_f32 v32, v10, s54, v32
    v_mul_f32 v10, 0x41000000, v30
    v_permlane32_swap_b32 v7, v8
    v_mul_f32 v12, 1.0, v30
    v_mul_f32 v14, 0x43800000, v30
    v_max_f32 v7, v7, v8
    v_mul_f32 v11, 0x41000000, v31
    v_mul_f32 v13, 1.0, v31
    v_mul_f32 v7, v7, v4
    v_mul_f32 v15, 0x43800000, v31
    v_add_f32 v7, v7, v7
    v_exp_f32 v10, v10
    v_exp_f32 v12, v12
    v_frexp_exp_i32_f32 v7, v7
    v_exp_f32 v14, v14
    v_fract_f32 v11, v11
    s_movk_i32 s49, 100
    v_fract_f32 v13, v13
    v_fract_f32 v15, v15
    s_movk_i32 s33, -100
    v_mul_f32 v36, 0x41000000, v32
    v_mul_f32 v34, 1.0, v32
    v_min_i32 v7, s49, v7
    v_mul_f32 v38, 0x43800000, v32
    v_max_i32 v7, s33, v7
    v_add_f32 v11, v11, v36
    v_add_f32 v13, v13, v34
    v_sub_u32 v8, 14, v7
    v_add_f32 v15, v15, v38
    v_cos_f32 v36, v11
    v_add_f32 v9, v4, v4
    v_cos_f32 v34, v13
    v_cos_f32 v38, v15
    v_ldexp_f32 v5, v9, v8
    v_sin_f32 v37, v11
    v_sin_f32 v35, v13
    v_subrev_u32 v8, 6, v7
    v_sin_f32 v39, v15
    v_ldexp_f32 v6, 1.0, v8
    v_pk_mul_f32 v[36:37], v[36:37], v[10:11] op_sel_hi:[1,0]
    v_pk_mul_f32 v[34:35], v[34:35], v[12:13] op_sel_hi:[1,0]
    v_pk_mul_f32 v[44:45], v[4:5], v[150:151] op_sel:[1,0] op_sel_hi:[1,1]
    v_pk_mul_f32 v[38:39], v[38:39], v[14:15] op_sel_hi:[1,0]
    v_pk_mul_f32 v[58:59], v[36:37], v[36:37] op_sel:[0,0] op_sel_hi:[0,1]
    v_pk_fma_f32 v[26:27], v[36:37], v[36:37], v[58:59] op_sel:[1,1,0] op_sel_hi:[1,0,1] neg_lo:[0,1,0]
    v_mov_b32 v62, 0x3c00
    ds_write_b32 v2, v62
    s_cmp_eq_u32 s20, 10
    s_cbranch_scc1 k12_nosig
    s_waitcnt vmcnt(0)
    v_mov_b32 v14, 163684
    v_mov_b32 v15, 1
    s_mov_b64 exec, 1
    ds_add_u32 v14, v15
    s_mov_b64 exec, -1
k12_nosig:
    v_cvt_pk_f16_f32 v68, v36, -v37
    v_cvt_pk_f16_f32 v64, v26, -v27
    ds_write_b32 v2, v68 offset:272
    ds_write_b32 v2, v64 offset:544
    v_pk_mul_f32 v[60:61], v[36:37], v[26:27] op_sel:[0,0] op_sel_hi:[0,1]
    v_pk_mul_f32 v[58:59], v[26:27], v[26:27] op_sel:[0,0] op_sel_hi:[0,1]
    v_pk_fma_f32 v[72:73], v[36:37], v[26:27], v[60:61] op_sel:[1,1,0] op_sel_hi:[1,0,1] neg_lo:[0,1,0]
    v_pk_fma_f32 v[54:55], v[26:27], v[26:27], v[58:59] op_sel:[1,1,0] op_sel_hi:[1,0,1] neg_lo:[0,1,0]
    v_cvt_pk_f16_f32 v69, v72, -v73
    v_cvt_pk_f16_f32 v65, v54, -v55
    ds_write_b32 v2, v69 offset:816
    ds_write_b32 v2, v65 offset:1088
    v_pk_mul_f32 v[60:61], v[72:73], v[26:27] op_sel:[0,0] op_sel_hi:[0,1]
    v_pk_mul_f32 v[58:59], v[54:55], v[26:27] op_sel:[0,0] op_sel_hi:[0,1]
    v_pk_fma_f32 v[74:75], v[72:73], v[26:27], v[60:61] op_sel:[1,1,0] op_sel_hi:[1,0,1] neg_lo:[0,1,0]
    v_pk_fma_f32 v[56:57], v[54:55], v[26:27], v[58:59] op_sel:[1,1,0] op_sel_hi:[1,0,1] neg_lo:[0,1,0]
    v_cvt_pk_f16_f32 v70, v74, -v75
    v_cvt_pk_f16_f32 v66, v56, -v57
    ds_write_b32 v2, v70 offset:1360
    ds_write_b32 v2, v66 offset:1632
    v_pk_mul_f32 v[60:61], v[74:75], v[26:27] op_sel:[0,0] op_sel_hi:[0,1]
    v_pk_mul_f32 v[58:59], v[56:57], v[26:27] op_sel:[0,0] op_sel_hi:[0,1]
    v_pk_fma_f32 v[72:73], v[74:75], v[26:27], v[60:61] op_sel:[1,1,0] op_sel_hi:[1,0,1] neg_lo:[0,1,0]
    v_pk_fma_f32 v[54:55], v[56:57], v[26:27], v[58:59] op_sel:[1,1,0] op_sel_hi:[1,0,1] neg_lo:[0,1,0]
    v_cvt_pk_f16_f32 v71, v72, -v73
    v_cvt_pk_f16_f32 v67, v54, -v55
    ds_write_b32 v2, v71 offset:1904
    ds_write_b32 v2, v67 offset:2176
    v_pk_mul_f32 v[60:61], v[72:73], v[26:27] op_sel:[0,0] op_sel_hi:[0,1]
    v_pk_mul_f32 v[58:59], v[54:55], v[26:27] op_sel:[0,0] op_sel_hi:[0,1]
    v_pk_fma_f32 v[74:75], v[72:73], v[26:27], v[60:61] op_sel:[1,1,0] op_sel_hi:[1,0,1] neg_lo:[0,1,0]
    v_cvt_pk_f16_f32 v68, v74, -v75
    v_pk_fma_f32 v[56:57], v[54:55], v[26:27], v[58:59] op_sel:[1,1,0] op_sel_hi:[1,0,1] neg_lo:[0,1,0]
    ds_write_b32 v2, v68 offset:2448
    v_cvt_pk_f16_f32 v64, v56, -v57
    v_pk_mul_f32 v[60:61], v[74:75], v[26:27] op_sel:[0,0] op_sel_hi:[0,1]
    ds_write_b32 v2, v64 offset:2720
    v_pk_fma_f32 v[72:73], v[74:75], v[26:27], v[60:61] op_sel:[1,1,0] op_sel_hi:[1,0,1] neg_lo:[0,1,0]
    v_pk_mul_f32 v[58:59], v[56:57], v[26:27] op_sel:[0,0] op_sel_hi:[0,1]
    v_cvt_pk_f16_f32 v69, v72, -v73
    v_pk_fma_f32 v[54:55], v[56:57], v[26:27], v[58:59] op_sel:[1,1,0] op_sel_hi:[1,0,1] neg_lo:[0,1,0]
    ds_write_b32 v2, v69 offset:2992
    v_cvt_pk_f16_f32 v65, v54, -v55
    v_pk_mul_f32 v[60:61], v[72:73], v[26:27] op_sel:[0,0] op_sel_hi:[0,1]
    ds_write_b32 v2, v65 offset:3264
    v_pk_fma_f32 v[74:75], v[72:73], v[26:27], v[60:61] op_sel:[1,1,0] op_sel_hi:[1,0,1] neg_lo:[0,1,0]
    v_pk_mul_f32 v[58:59], v[54:55], v[26:27] op_sel:[0,0] op_sel_hi:[0,1]
    v_cvt_pk_f16_f32 v70, v74, -v75
    v_pk_fma_f32 v[56:57], v[54:55], v[26:27], v[58:59] op_sel:[1,1,0] op_sel_hi:[1,0,1] neg_lo:[0,1,0]
    ds_write_b32 v2, v70 offset:3536
    v_cvt_pk_f16_f32 v66, v56, -v57
    v_pk_mul_f32 v[60:61], v[74:75], v[26:27] op_sel:[0,0] op_sel_hi:[0,1]
    ds_write_b32 v2, v66 offset:3808
    v_pk_fma_f32 v[72:73], v[74:75], v[26:27], v[60:61] op_sel:[1,1,0] op_sel_hi:[1,0,1] neg_lo:[0,1,0]
    v_pk_mul_f32 v[58:59], v[56:57], v[26:27] op_sel:[0,0] op_sel_hi:[0,1]
    v_cvt_pk_f16_f32 v71, v72, -v73
    v_pk_fma_f32 v[54:55], v[56:57], v[26:27], v[58:59] op_sel:[1,1,0] op_sel_hi:[1,0,1] neg_lo:[0,1,0]
    ds_write_b32 v2, v71 offset:4080
    v_cvt_pk_f16_f32 v67, v54, -v55
    v_pk_mul_f32 v[60:61], v[72:73], v[26:27] op_sel:[0,0] op_sel_hi:[0,1]
    v_pk_fma_f32 v[74:75], v[72:73], v[26:27], v[60:61] op_sel:[1,1,0] op_sel_hi:[1,0,1] neg_lo:[0,1,0]
    ds_write_b32 v2, v67 offset:4352
    v_cvt_pk_f16_f32 v68, v74, -v75
    v_pk_mul_f32 v[58:59], v[54:55], v[26:27] op_sel:[0,0] op_sel_hi:[0,1]
    ds_write_b32 v2, v68 offset:4624
    v_pk_fma_f32 v[56:57], v[54:55], v[26:27], v[58:59] op_sel:[1,1,0] op_sel_hi:[1,0,1] neg_lo:[0,1,0]
    v_pk_mul_f32 v[60:61], v[74:75], v[26:27] op_sel:[0,0] op_sel_hi:[0,1]
    v_cvt_pk_f16_f32 v64, v56, -v57
    v_pk_fma_f32 v[72:73], v[74:75], v[26:27], v[60:61] op_sel:[1,1,0] op_sel_hi:[1,0,1] neg_lo:[0,1,0]
    ds_write_b32 v2, v64 offset:4896
    v_cvt_pk_f16_f32 v69, v72, -v73
    v_pk_mul_f32 v[58:59], v[56:57], v[26:27] op_sel:[0,0] op_sel_hi:[0,1]
    ds_write_b32 v2, v69 offset:5168
    v_pk_fma_f32 v[54:55], v[56:57], v[26:27], v[58:59] op_sel:[1,1,0] op_sel_hi:[1,0,1] neg_lo:[0,1,0]
    v_pk_mul_f32 v[60:61], v[72:73], v[26:27] op_sel:[0,0] op_sel_hi:[0,1]
    v_cvt_pk_f16_f32 v65, v54, -v55
    v_pk_fma_f32 v[74:75], v[72:73], v[26:27], v[60:61] op_sel:[1,1,0] op_sel_hi:[1,0,1] neg_lo:[0,1,0]
    ds_write_b32 v2, v65 offset:5440
    v_cvt_pk_f16_f32 v70, v74, -v75
    v_pk_mul_f32 v[58:59], v[54:55], v[26:27] op_sel:[0,0] op_sel_hi:[0,1]
    ds_write_b32 v2, v70 offset:5712
    v_pk_fma_f32 v[56:57], v[54:55], v[26:27], v[58:59] op_sel:[1,1,0] op_sel_hi:[1,0,1] neg_lo:[0,1,0]
    v_pk_mul_f32 v[60:61], v[74:75], v[26:27] op_sel:[0,0] op_sel_hi:[0,1]
    v_cvt_pk_f16_f32 v66, v56, -v57
    v_pk_fma_f32 v[72:73], v[74:75], v[26:27], v[60:61] op_sel:[1,1,0] op_sel_hi:[1,0,1] neg_lo:[0,1,0]
    ds_write_b32 v2, v66 offset:5984
    v_cvt_pk_f16_f32 v71, v72, -v73
    v_pk_mul_f32 v[58:59], v[56:57], v[26:27] op_sel:[0,0] op_sel_hi:[0,1]
    ds_write_b32 v2, v71 offset:6256
    v_pk_fma_f32 v[54:55], v[56:57], v[26:27], v[58:59] op_sel:[1,1,0] op_sel_hi:[1,0,1] neg_lo:[0,1,0]
    v_pk_mul_f32 v[60:61], v[72:73], v[26:27] op_sel:[0,0] op_sel_hi:[0,1]
    v_pk_fma_f32 v[74:75], v[72:73], v[26:27], v[60:61] op_sel:[1,1,0] op_sel_hi:[1,0,1] neg_lo:[0,1,0]
    v_cvt_pk_f16_f32 v67, v54, -v55
    v_cvt_pk_f16_f32 v68, v74, -v75
    ds_write_b32 v2, v67 offset:6528
    ds_write_b32 v2, v68 offset:6800
    v_pk_mul_f32 v[58:59], v[54:55], v[26:27] op_sel:[0,0] op_sel_hi:[0,1]
    v_pk_mul_f32 v[60:61], v[74:75], v[26:27] op_sel:[0,0] op_sel_hi:[0,1]
    v_pk_fma_f32 v[56:57], v[54:55], v[26:27], v[58:59] op_sel:[1,1,0] op_sel_hi:[1,0,1] neg_lo:[0,1,0]
    v_pk_fma_f32 v[72:73], v[74:75], v[26:27], v[60:61] op_sel:[1,1,0] op_sel_hi:[1,0,1] neg_lo:[0,1,0]
    v_cvt_pk_f16_f32 v64, v56, -v57
    v_cvt_pk_f16_f32 v69, v72, -v73
    ds_write_b32 v2, v64 offset:7072
    ds_write_b32 v2, v69 offset:7344
    v_pk_mul_f32 v[58:59], v[56:57], v[26:27] op_sel:[0,0] op_sel_hi:[0,1]
    v_pk_mul_f32 v[60:61], v[72:73], v[26:27] op_sel:[0,0] op_sel_hi:[0,1]
    v_pk_fma_f32 v[54:55], v[56:57], v[26:27], v[58:59] op_sel:[1,1,0] op_sel_hi:[1,0,1] neg_lo:[0,1,0]
    v_pk_fma_f32 v[74:75], v[72:73], v[26:27], v[60:61] op_sel:[1,1,0] op_sel_hi:[1,0,1] neg_lo:[0,1,0]
    v_cvt_pk_f16_f32 v65, v54, -v55
    v_cvt_pk_f16_f32 v70, v74, -v75
    ds_write_b32 v2, v65 offset:7616
    ds_write_b32 v2, v70 offset:7888
    v_pk_mul_f32 v[58:59], v[54:55], v[26:27] op_sel:[0,0] op_sel_hi:[0,1]
    v_pk_mul_f32 v[60:61], v[74:75], v[26:27] op_sel:[0,0] op_sel_hi:[0,1]
    v_pk_fma_f32 v[56:57], v[54:55], v[26:27], v[58:59] op_sel:[1,1,0] op_sel_hi:[1,0,1] neg_lo:[0,1,0]
    v_pk_fma_f32 v[72:73], v[74:75], v[26:27], v[60:61] op_sel:[1,1,0] op_sel_hi:[1,0,1] neg_lo:[0,1,0]
    v_cvt_pk_f16_f32 v66, v56, -v57
    v_cvt_pk_f16_f32 v71, v72, -v73
    ds_write_b32 v2, v66 offset:8160
    ds_write_b32 v2, v71 offset:8432
    ds_read_b128 v[128:131], v3 offset:0
    ds_read_b128 v[132:135], v3 offset:32
    ds_read_b128 v[136:139], v3 offset:64
    ds_read_b128 v[140:143], v3 offset:96
    ds_read_b128 v[144:147], v3 offset:128
    ds_read_b128 v[148:151], v3 offset:160
    ds_read_b128 v[152:155], v3 offset:192
    ds_read_b128 v[156:159], v3 offset:224
    v_mov_b32 v14, 163744
    v_mov_b32 v15, 1
    s_mov_b64 exec, 1
    ds_add_u32 v14, v15
    s_mov_b64 exec, -1
    s_setprio 2
    v_cvt_pk_f16_f32 v67, v44, v45
    v_mul_f32 v60, v44, v38
    ds_write_b32 v2, v67 offset:0
    v_mul_f32 v61, v44, v39
    v_mul_f32 v58, v44, v34
    v_fma_f32 v54, -v45, v39, v60
    v_mul_f32 v59, v44, v35
    v_fma_f32 v55, v45, v38, v61
    v_fma_f32 v46, -v45, v35, v58
    v_cvt_pk_f16_f32 v68, v54, v55
    v_fma_f32 v47, v45, v34, v59
    v_cvt_pk_f16_f32 v64, v46, v47
    ds_write_b32 v2, v68 offset:1088
    ds_write_b32 v2, v64 offset:272
    ds_write_b32 v2, v68 offset:1360
    v_mul_f32 v58, v46, v34
    v_mul_f32 v60, v54, v38
    v_mul_f32 v59, v46, v35
    v_mul_f32 v61, v54, v39
    v_fma_f32 v48, -v47, v35, v58
    v_fma_f32 v56, -v55, v39, v60
    v_fma_f32 v49, v47, v34, v59
    v_cvt_pk_f16_f32 v65, v48, v49
    v_fma_f32 v57, v55, v38, v61
    ds_write_b32 v2, v65 offset:544
    v_cvt_pk_f16_f32 v69, v56, v57
    v_mul_f32 v58, v48, v34
    ds_write_b32 v2, v69 offset:4352
    v_mul_f32 v59, v48, v35
    v_mul_f32 v60, v56, v38
    v_fma_f32 v46, -v49, v35, v58
    v_fma_f32 v47, v49, v34, v59
    v_mul_f32 v61, v56, v39
    v_cvt_pk_f16_f32 v66, v46, v47
    v_fma_f32 v72, -v57, v39, v60
    ds_write_b32 v2, v66 offset:816
    v_fma_f32 v73, v57, v38, v61
    v_mul_f32 v58, v46, v34
    v_cvt_pk_f16_f32 v70, v72, v73
    v_mul_f32 v59, v46, v35
    ds_write_b32 v2, v70 offset:5440
    v_fma_f32 v48, -v47, v35, v58
    v_fma_f32 v49, v47, v34, v59
    v_mul_f32 v60, v72, v38
    v_cvt_pk_f16_f32 v67, v48, v49
    v_mul_f32 v61, v72, v39
    ds_write_b32 v2, v67 offset:2176
    v_fma_f32 v74, -v73, v39, v60
    v_mul_f32 v58, v48, v34
    v_fma_f32 v75, v73, v38, v61
    v_mul_f32 v59, v48, v35
    v_cvt_pk_f16_f32 v71, v74, v75
    v_fma_f32 v46, -v49, v35, v58
    v_fma_f32 v47, v49, v34, v59
    ds_write_b32 v2, v71 offset:5168
    v_cvt_pk_f16_f32 v64, v46, v47
    v_mul_f32 v60, v74, v38
    ds_write_b32 v2, v64 offset:2448
    v_mul_f32 v61, v74, v39
    v_mul_f32 v58, v46, v34
    v_fma_f32 v50, -v75, v39, v60
    v_mul_f32 v59, v46, v35
    v_fma_f32 v51, v75, v38, v61
    v_fma_f32 v48, -v47, v35, v58
    v_fma_f32 v49, v47, v34, v59
    v_cvt_pk_f16_f32 v68, v50, v51
    v_cvt_pk_f16_f32 v65, v48, v49
    ds_write_b32 v2, v68 offset:6800
    ds_write_b32 v2, v65 offset:2720
    v_mul_f32 v60, v50, v38
    v_mul_f32 v58, v48, v34
    v_mul_f32 v61, v50, v39
    v_mul_f32 v59, v48, v35
    v_fma_f32 v46, -v49, v35, v58
    v_fma_f32 v52, -v51, v39, v60
    v_fma_f32 v47, v49, v34, v59
    v_fma_f32 v53, v51, v38, v61
    v_cvt_pk_f16_f32 v66, v46, v47
    v_cvt_pk_f16_f32 v69, v52, v53
    ds_write_b32 v2, v66 offset:2992
    ds_write_b32 v2, v69 offset:6256
    v_mul_f32 v58, v34, v34
    v_mul_f32 v60, v52, v38
    v_mul_f32 v59, v34, v35
    v_fma_f32 v40, -v35, v35, v58
    v_mul_f32 v61, v52, v39
    v_fma_f32 v41, v35, v34, v59
    v_fma_f32 v76, -v53, v39, v60
    v_mul_f32 v58, v40, v40
    v_fma_f32 v77, v53, v38, v61
    v_mul_f32 v59, v40, v41
    v_cvt_pk_f16_f32 v70, v76, v77
    v_fma_f32 v42, -v41, v41, v58
    ds_write_b32 v2, v70 offset:7888
    v_fma_f32 v43, v41, v40, v59
    v_mul_f32 v60, v56, v42
    v_mul_f32 v58, v54, v40
    v_mul_f32 v61, v56, v43
    v_mul_f32 v59, v54, v41
    v_fma_f32 v78, -v57, v43, v60
    v_fma_f32 v46, -v55, v41, v58
    v_fma_f32 v79, v57, v42, v61
    v_cvt_pk_f16_f32 v71, v78, v79
    v_fma_f32 v47, v55, v40, v59
    ds_write_b32 v2, v71 offset:4624
    v_cvt_pk_f16_f32 v67, v46, v47
    v_mul_f32 v60, v78, v42
    ds_write_b32 v2, v67 offset:1632
    v_mul_f32 v61, v78, v43
    v_fma_f32 v28, -v79, v43, v60
    v_mul_f32 v58, v46, v40
    v_fma_f32 v29, v79, v42, v61
    v_mul_f32 v59, v46, v41
    v_cvt_pk_f16_f32 v68, v28, v29
    v_fma_f32 v48, -v47, v41, v58
    ds_write_b32 v2, v68 offset:4896
    v_fma_f32 v49, v47, v40, v59
    v_mul_f32 v60, v72, v42
    v_mul_f32 v61, v72, v43
    v_cvt_pk_f16_f32 v64, v48, v49
    v_fma_f32 v78, -v73, v43, v60
    ds_write_b32 v2, v64 offset:1904
    v_fma_f32 v79, v73, v42, v61
    ds_write_b32 v2, v64 offset:3264
    v_cvt_pk_f16_f32 v69, v78, v79
    ds_write_b32 v2, v69 offset:5712
    ds_write_b32 v2, v64 offset:3536
    v_mul_f32 v60, v78, v42
    v_mul_f32 v58, v48, v40
    v_mul_f32 v61, v78, v43
    v_mul_f32 v59, v48, v41
    v_fma_f32 v28, -v79, v43, v60
    v_fma_f32 v29, v79, v42, v61
    v_fma_f32 v46, -v49, v41, v58
    v_cvt_pk_f16_f32 v70, v28, v29
    v_fma_f32 v47, v49, v40, v59
    ds_write_b32 v2, v70 offset:5984
    v_cvt_pk_f16_f32 v65, v46, v47
    v_mul_f32 v60, v50, v36
    v_mul_f32 v61, v50, v37
    ds_write_b32 v2, v65 offset:3808
    v_fma_f32 v78, -v51, v37, v60
    v_mul_f32 v58, v46, v40
    v_fma_f32 v79, v51, v36, v61
    v_mul_f32 v59, v46, v41
    v_cvt_pk_f16_f32 v71, v78, v79
    ds_write_b32 v2, v71 offset:7072
    v_fma_f32 v48, -v47, v41, v58
    v_mul_f32 v60, v52, v36
    v_fma_f32 v49, v47, v40, v59
    v_mul_f32 v61, v52, v37
    v_cvt_pk_f16_f32 v66, v48, v49
    v_fma_f32 v78, -v53, v37, v60
    ds_write_b32 v2, v66 offset:4080
    v_fma_f32 v79, v53, v36, v61
    v_cvt_pk_f16_f32 v68, v78, v79
    v_mul_f32 v58, v74, v36
    ds_write_b32 v2, v68 offset:7616
    v_mul_f32 v59, v74, v37
    v_mul_f32 v60, v76, v36
    v_fma_f32 v46, -v75, v37, v58
    v_mul_f32 v61, v76, v37
    v_fma_f32 v78, -v77, v37, v60
    v_fma_f32 v47, v75, v36, v59
    v_fma_f32 v79, v77, v36, v61
    v_cvt_pk_f16_f32 v67, v46, v47
    v_cvt_pk_f16_f32 v69, v78, v79
    ds_write_b32 v2, v67 offset:6528
    ds_write_b32 v2, v69 offset:8160
    ds_read_b128 v[96:99], v3 offset:0
    ds_read_b128 v[100:103], v3 offset:32
    ds_read_b128 v[104:107], v3 offset:64
    ds_read_b128 v[108:111], v3 offset:96
    ds_read_b128 v[112:115], v3 offset:128
    ds_read_b128 v[116:119], v3 offset:160
    ds_read_b128 v[120:123], v3 offset:192
    ds_read_b128 v[124:127], v3 offset:224
    v_and_b32 v7, 31, v0
    v_lshrrev_b32 v8, 5, v0
    v_lshlrev_b32 v7, 4, v7
    s_mul_i32 s34, s56, 16640
    s_add_u32 s34, s34, 15456
    v_add_u32 v7, s34, v7
    v_lshl_add_u32 v10, v8, 9, v7
    v_lshl_add_u32 v11, v8, 10, v7
    v_bfe_u32 v12, v0, 2, 2
    v_mul_u32_u24 v12, 4160, v12
    v_and_b32 v13, 3, v0
    v_lshl_add_u32 v12, v13, 4, v12
    v_add_u32 v12, s34, v12
    s_lshl_b32 s34, s56, 2
    s_add_u32 s36, s34, 163760
    v_mov_b32 v13, s36
    s_add_u32 s34, s34, 163700
    v_and_b32 v8, 1, v0
    v_cmp_eq_u32 vcc, 1, v8
    s_waitcnt lgkmcnt(7)
    v_mfma_f32_32x32x16_f16 v[80:95], v[96:99], v[128:131], 0
    s_waitcnt lgkmcnt(6)
    v_mfma_f32_32x32x16_f16 v[80:95], v[100:103], v[132:135], v[80:95]
    s_waitcnt lgkmcnt(5)
    v_mfma_f32_32x32x16_f16 v[80:95], v[104:107], v[136:139], v[80:95]
    s_waitcnt lgkmcnt(4)
    v_mfma_f32_32x32x16_f16 v[80:95], v[108:111], v[140:143], v[80:95]
    s_waitcnt lgkmcnt(3)
    v_mfma_f32_32x32x16_f16 v[80:95], v[112:115], v[144:147], v[80:95]
    s_waitcnt lgkmcnt(2)
    v_mfma_f32_32x32x16_f16 v[80:95], v[116:119], v[148:151], v[80:95]
    s_waitcnt lgkmcnt(1)
    v_mfma_f32_32x32x16_f16 v[80:95], v[120:123], v[152:155], v[80:95]
    s_waitcnt lgkmcnt(0)
    v_mfma_f32_32x32x16_f16 v[80:95], v[124:127], v[156:159], v[80:95]
    v_lshl_add_u32 v9, v0, 4, s55
    s_lshl_b32 s33, s56, 2
    s_add_u32 s33, s33, 163688
    s_cmp_eq_u32 s57, 0
    s_cbranch_scc1 k12_sum
    s_nop 6
    ds_write_b128 v9, v[80:83] offset:0
    ds_write_b128 v9, v[84:87] offset:1024
    ds_write_b128 v9, v[88:91] offset:2048
    ds_write_b128 v9, v[92:95] offset:3072
    v_mov_b32 v14, s33
    v_mov_b32 v15, 1
    s_mov_b64 exec, 1
    ds_add_u32 v14, v15
    s_mov_b64 exec, -1
    s_branch k12_conv
k12_sum:
    v_mov_b32 v14, s33
    s_mov_b32 s68, 0x40000
k12_s1:
    s_sub_u32 s68, s68, 1
    s_cbranch_scc1 k12_s1_x
    ds_read_b32 v15, v14
    s_waitcnt lgkmcnt(0)
    v_readfirstlane_b32 s49, v15
    s_nop 0
    s_cmp_lt_u32 s49, 2
    s_cbranch_scc1 k12_s1
k12_s1_x:
    s_setprio 2
    ds_read_b128 v[96:99], v9 offset:17408
    ds_read_b128 v[100:103], v9 offset:18432
    ds_read_b128 v[104:107], v9 offset:19456
    ds_read_b128 v[108:111], v9 offset:20480
    s_waitcnt lgkmcnt(3)
    v_add_f32 v80, v80, v96
    v_add_f32 v81, v81, v97
    v_add_f32 v82, v82, v98
    v_add_f32 v83, v83, v99
    s_waitcnt lgkmcnt(2)
    v_add_f32 v84, v84, v100
    v_add_f32 v85, v85, v101
    v_add_f32 v86, v86, v102
    v_add_f32 v87, v87, v103
    s_waitcnt lgkmcnt(1)
    v_add_f32 v88, v88, v104
    v_add_f32 v89, v89, v105
    v_add_f32 v90, v90, v106
    v_add_f32 v91, v91, v107
    s_waitcnt lgkmcnt(0)
    v_add_f32 v92, v92, v108
    v_add_f32 v93, v93, v109
    v_add_f32 v94, v94, v110
    v_add_f32 v95, v95, v111
    ds_read_b128 v[96:99], v9 offset:8704
    ds_read_b128 v[100:103], v9 offset:9728
    ds_read_b128 v[104:107], v9 offset:10752
    ds_read_b128 v[108:111], v9 offset:11776
    s_mov_b32 s60, 0x3b800000
    v_mov_b32 v16, 0
    v_mov_b32 v17, 0
    v_mov_b32 v18, 0
    v_mov_b32 v19, 0
    ds_write_b128 v12, v[16:19]
    ds_write_b32 v13, v6
    s_waitcnt lgkmcnt(5)
    v_add_f32 v80, v80, v96
    v_add_f32 v81, v81, v97
    v_add_f32 v82, v82, v98
    v_add_f32 v83, v83, v99
    s_waitcnt lgkmcnt(4)
    v_add_f32 v84, v84, v100
    v_add_f32 v85, v85, v101
    v_add_f32 v86, v86, v102
    v_add_f32 v87, v87, v103
    s_waitcnt lgkmcnt(3)
    v_add_f32 v88, v88, v104
    v_add_f32 v89, v89, v105
    v_add_f32 v90, v90, v106
    v_add_f32 v91, v91, v107
    s_waitcnt lgkmcnt(2)
    v_add_f32 v92, v92, v108
    v_add_f32 v93, v93, v109
    v_add_f32 v94, v94, v110
    v_add_f32 v95, v95, v111
    v_mul_f32 v80, s60, v80
    v_mul_f32 v81, s60, v81
    v_mul_f32 v82, s60, v82
    v_mul_f32 v83, s60, v83
    v_mul_f32 v84, s60, v84
    v_mul_f32 v85, s60, v85
    v_mul_f32 v86, s60, v86
    v_mul_f32 v87, s60, v87
    v_mul_f32 v88, s60, v88
    v_mul_f32 v89, s60, v89
    v_mul_f32 v90, s60, v90
    v_mul_f32 v91, s60, v91
    v_mul_f32 v92, s60, v92
    v_mul_f32 v93, s60, v93
    v_mul_f32 v94, s60, v94
    v_cndmask_b32 v7, v91, v92, vcc
    v_cndmask_b32 v8, v93, v94, vcc
    v_cvt_pk_f16_f32 v20, v80, v81
    v_cvt_pk_f16_f32 v21, v82, v83
    v_cvt_pk_f16_f32 v22, v84, v85
    v_cvt_pk_f16_f32 v23, v86, v87
    ds_write_b128 v10, v[20:23] offset:64
    v_cvt_pk_f16_f32 v24, v88, v88
    v_cvt_pk_f16_f32 v25, v88, v89
    v_cvt_pk_f16_f32 v26, v89, v89
    v_cvt_pk_f16_f32 v27, v90, v90
    ds_write_b128 v10, v[24:27] offset:1088
    v_cvt_pk_f16_f32 v28, v91, v91
    v_cvt_pk_f16_f32 v29, v91, v91
    v_cvt_pk_f16_f32 v30, v7, v92
    v_cvt_pk_f16_f32 v31, v92, v92
    ds_write_b128 v11, v[28:31] offset:2112
    v_cvt_pk_f16_f32 v32, v93, v93
    v_cvt_pk_f16_f32 v33, v93, v93
    v_cvt_pk_f16_f32 v34, v8, v94
    v_cvt_pk_f16_f32 v35, v94, v94
    ds_write_b128 v11, v[32:35] offset:2624
    v_mov_b32 v14, s34
    v_mov_b32 v15, 1
    s_mov_b64 exec, 1
    ds_add_u32 v14, v15
    s_mov_b64 exec, -1
    s_branch k12_conv
k12_aux:
    s_waitcnt vmcnt(0)
    v_mov_b32 v14, 163684
    v_mov_b32 v15, 1
    s_mov_b64 exec, 1
    ds_add_u32 v14, v15
    s_mov_b64 exec, -1
    s_cmp_lt_u32 s20, 8
    s_cbranch_scc1 k12_touch
    v_readfirstlane_b32 s39, v160
    s_nop 0
    s_mul_i32 s39, s39, 0x9e3779b1
    s_add_u32 s39, s39, 0x7f4a7c15
k12_gsetup:
    s_add_u32 s28, s16, 19726336
    s_addc_u32 s29, s17, 0
    s_mov_b32 s30, 65536
    s_mov_b32 s31, 0x20000
    s_setprio 0
    v_lshrrev_b32 v2, 2, v0
    v_and_b32 v3, 3, v0
    v_mul_u32_u24 v1, 40960, v2
    v_lshl_add_u32 v1, v3, 4, v1
    v_mul_u32_u24 v4, 5152, v3
    v_lshl_add_u32 v4, v2, 4, v4
    s_sub_u32 s33, s20, 8
    s_mul_i32 s33, s33, 11
    s_add_u32 s33, s33, 1
    s_lshr_b32 s33, s33, 1
    s_min_u32 s33, s33, 11
    s_lshl_b32 s23, s21, 4
    s_mov_b32 s34, 0x33333333
    s_cmp_eq_u32 s22, 3
    s_cselect_b32 s34, 0x77777777, s34
    s_cmp_ge_u32 s20, 10
    s_cbranch_scc1 k12_gwait
    v_mov_b32 v14, 163684
    s_waitcnt lgkmcnt(0)
    s_mov_b32 s68, 0x40000
k12_s3:
    s_sub_u32 s68, s68, 1
    s_cbranch_scc1 k12_s3_x
    ds_read_b32 v15, v14
    s_waitcnt lgkmcnt(0)
    v_readfirstlane_b32 s49, v15
    s_nop 0
    s_cmp_lt_u32 s49, 10
    s_cbranch_scc1 k12_s3
k12_s3_x:
    s_cmp_eq_u32 s20, 8
    s_cbranch_scc1 k12_poll
    v_lshrrev_b32 v6, 4, v0
    v_mul_u32_u24 v6, 1280, v6
    v_and_b32 v7, 15, v0
    v_lshl_add_u32 v6, v7, 4, v6
    v_mov_b32 v8, 0
    v_mov_b32 v9, 0
    v_mov_b32 v10, 0
    v_mov_b32 v11, 0
    ds_write_b128 v6, v[8:11] offset:0
    ds_write_b128 v6, v[8:11] offset:5152
    ds_write_b128 v6, v[8:11] offset:10304
k12_gwait:
    v_mov_b32 v14, 163740
    s_waitcnt lgkmcnt(0)
    s_mov_b32 s68, 0x40000
k12_s4:
    s_sub_u32 s68, s68, 1
    s_cbranch_scc1 k12_s4_x
    ds_read_b32 v15, v14
    s_waitcnt lgkmcnt(0)
    v_readfirstlane_b32 s49, v15
    s_nop 0
    s_cmp_lt_u32 s49, 1
    s_cbranch_scc1 k12_s4
k12_s4_x:
    s_cmp_eq_u32 s20, 10
    s_cbranch_scc1 k12_nogather
    s_branch k12_gather
k12_poll:
    s_and_b32 s49, s2, 63
    s_lshl_b32 s49, s49, 7
    s_lshr_b32 s35, s2, 6
    s_lshl_b32 s35, s35, 2
    s_add_u32 s35, s35, s49
    v_mov_b32 v8, s39
    s_mov_b64 exec, 1
    buffer_store_dword v8, off, s[28:31], s35 sc1
    s_mov_b32 s36, 0
    s_mov_b64 exec, -1
    v_lshlrev_b32 v6, 2, v0
    v_lshrrev_b32 v7, 2, v6
    v_and_b32 v6, 3, v6
    v_lshlrev_b32 v6, 2, v6
    v_lshl_add_u32 v6, v7, 7, v6
    v_mov_b32 v14, 163744
    s_mov_b32 s68, 0x40000
k12_sy:
    s_sub_u32 s68, s68, 1
    s_cbranch_scc1 k12_sy_x
    ds_read_b32 v15, v14
    s_waitcnt lgkmcnt(0)
    v_readfirstlane_b32 s49, v15
    s_nop 0
    s_cmp_lt_u32 s49, 6
    s_cbranch_scc1 k12_sy
k12_sy_x:
    s_setprio 3
    s_mov_b32 s68, 0x100000
k12_flp:
    s_sub_u32 s68, s68, 1
    s_cbranch_scc1 k12_flx
    buffer_load_dwordx4 v[8:11], v6, s[28:31], s36 offen sc1
    s_waitcnt vmcnt(0)
    v_cmp_ne_u32 vcc, s39, v8
    v_cmp_ne_u32 s[44:45], s39, v9
    v_cmp_ne_u32 s[46:47], s39, v10
    v_cmp_ne_u32 s[50:51], s39, v11
    s_or_b64 vcc, vcc, s[44:45]
    s_or_b64 s[46:47], s[46:47], s[50:51]
    s_or_b64 vcc, vcc, s[46:47]
    s_cbranch_scc1 k12_flp
k12_flx:
    v_mov_b32 v14, 163740
    v_mov_b32 v15, 1
    s_mov_b64 exec, 1
    ds_add_u32 v14, v15
    s_mov_b64 exec, -1
    s_cmp_lg_u32 s2, 0
    s_cbranch_scc1 k12_gather
    s_add_u32 s28, s16, 19791872
    s_addc_u32 s29, s17, 0
    s_mov_b32 s30, 4
    s_mov_b32 s31, 0x20000
    s_mov_b64 exec, 1
    buffer_store_dword v8, off, s[28:31], 0 sc1
    s_mov_b64 exec, -1
k12_gather:
    s_setprio 3
    s_mov_b32 exec_lo, s34
    s_mov_b32 exec_hi, s34
    s_add_u32 s35, s33, 0
    s_min_u32 s35, s35, 15
    s_and_b32 s36, s35, 3
    s_lshr_b32 s35, s35, 2
    s_lshl_b32 s37, s35, 6
    s_add_u32 s37, s37, s36
    s_mul_i32 s37, s37, 10240
    s_add_u32 s37, s37, s23
    buffer_load_dwordx4 v[16:19], v1, s[24:27], s37 offen sc1
    s_mul_i32 s36, s36, 1280
    s_lshl_b32 s35, s35, 8
    s_add_u32 s35, s35, s36
    v_add_u32 v8, s35, v4
    s_add_u32 s35, s33, 1
    s_min_u32 s35, s35, 15
    s_and_b32 s36, s35, 3
    s_lshr_b32 s35, s35, 2
    s_lshl_b32 s37, s35, 6
    s_add_u32 s37, s37, s36
    s_mul_i32 s37, s37, 10240
    s_add_u32 s37, s37, s23
    buffer_load_dwordx4 v[20:23], v1, s[24:27], s37 offen sc1
    s_mul_i32 s36, s36, 1280
    s_lshl_b32 s35, s35, 8
    s_add_u32 s35, s35, s36
    v_add_u32 v9, s35, v4
    s_add_u32 s35, s33, 2
    s_min_u32 s35, s35, 15
    s_and_b32 s36, s35, 3
    s_lshr_b32 s35, s35, 2
    s_lshl_b32 s37, s35, 6
    s_add_u32 s37, s37, s36
    s_mul_i32 s37, s37, 10240
    s_add_u32 s37, s37, s23
    buffer_load_dwordx4 v[24:27], v1, s[24:27], s37 offen sc1
    s_mul_i32 s36, s36, 1280
    s_lshl_b32 s35, s35, 8
    s_add_u32 s35, s35, s36
    v_add_u32 v10, s35, v4
    s_add_u32 s35, s33, 3
    s_min_u32 s35, s35, 15
    s_and_b32 s36, s35, 3
    s_lshr_b32 s35, s35, 2
    s_lshl_b32 s37, s35, 6
    s_add_u32 s37, s37, s36
    s_mul_i32 s37, s37, 10240
    s_add_u32 s37, s37, s23
    buffer_load_dwordx4 v[28:31], v1, s[24:27], s37 offen sc1
    s_mul_i32 s36, s36, 1280
    s_lshl_b32 s35, s35, 8
    s_add_u32 s35, s35, s36
    v_add_u32 v11, s35, v4
    s_add_u32 s35, s33, 4
    s_min_u32 s35, s35, 15
    s_and_b32 s36, s35, 3
    s_lshr_b32 s35, s35, 2
    s_lshl_b32 s37, s35, 6
    s_add_u32 s37, s37, s36
    s_mul_i32 s37, s37, 10240
    s_add_u32 s37, s37, s23
    buffer_load_dwordx4 v[32:35], v1, s[24:27], s37 offen sc1
    s_mul_i32 s36, s36, 1280
    s_lshl_b32 s35, s35, 8
    s_add_u32 s35, s35, s36
    v_add_u32 v12, s35, v4
    s_add_u32 s35, s33, 5
    s_min_u32 s35, s35, 15
    s_and_b32 s36, s35, 3
    s_lshr_b32 s35, s35, 2
    s_lshl_b32 s37, s35, 6
    s_add_u32 s37, s37, s36
    s_mul_i32 s37, s37, 10240
    s_add_u32 s37, s37, s23
    buffer_load_dwordx4 v[36:39], v1, s[24:27], s37 offen sc1
    s_mul_i32 s36, s36, 1280
    s_lshl_b32 s35, s35, 8
    s_add_u32 s35, s35, s36
    v_add_u32 v13, s35, v4
    s_waitcnt vmcnt(5)
    ds_write_b128 v8, v[16:19] offset:256
    s_waitcnt vmcnt(4)
    ds_write_b128 v9, v[20:23] offset:256
    s_waitcnt vmcnt(3)
    ds_write_b128 v10, v[24:27] offset:256
    s_waitcnt vmcnt(2)
    ds_write_b128 v11, v[28:31] offset:256
    s_waitcnt vmcnt(1)
    ds_write_b128 v12, v[32:35] offset:256
    s_waitcnt vmcnt(0)
    ds_write_b128 v13, v[36:39] offset:256
    s_mov_b64 exec, -1
    v_mov_b32 v14, 163712
    v_mov_b32 v15, 1
    s_mov_b64 exec, 1
    ds_add_u32 v14, v15
    s_mov_b64 exec, -1
k12_nogather:
    s_setprio 0
    s_cmp_eq_u32 s59, 0
    s_cbranch_scc1 k12_conv
    s_lshr_b32 s33, s2, 4
    s_lshl_b32 s33, s33, 2
    s_add_u32 s33, s33, s20
    s_add_u32 s33, s33, 24
    s_mov_b32 s61, 0
    s_lshl_b32 s55, s20, 13
    s_add_u32 s49, s55, 4294950496
    s_add_u32 s55, s55, 65376
    s_cmp_lt_u32 s20, 10
    s_cselect_b32 s55, s49, s55
    v_mov_b32 v14, 163712
    s_waitcnt lgkmcnt(0)
    s_mov_b32 s68, 0x40000
k12_sw:
    s_sub_u32 s68, s68, 1
    s_cbranch_scc1 k12_sw_x
    ds_read_b32 v15, v14
    s_waitcnt lgkmcnt(0)
    v_readfirstlane_b32 s49, v15
    s_nop 0
    s_cmp_lt_u32 s49, 3
    s_cbranch_scc1 k12_sw
k12_sw_x:
    s_branch k12_rl
k12_touch:
    s_load_dwordx2 s[10:11], s[0:1], 88
    s_cmp_ge_u32 s2, 16
    s_cbranch_scc1 k12_noflags
    s_add_u32 s28, s16, 19070976
    s_addc_u32 s29, s17, 0
    s_mov_b32 s30, 8192
    s_mov_b32 s31, 0x20000
    v_mov_b32 v4, 0
    v_mov_b32 v5, 0
    v_mov_b32 v6, 0
    v_mov_b32 v7, 0
    v_lshlrev_b32 v1, 4, v0
    s_mov_b32 s49, 0
    buffer_store_dwordx4 v[4:7], v1, s[28:31], s49 offen offset:0
    s_mov_b32 s49, 0
    buffer_store_dwordx4 v[4:7], v1, s[28:31], s49 offen offset:1024
    s_mov_b32 s49, 0
    buffer_store_dwordx4 v[4:7], v1, s[28:31], s49 offen offset:2048
    s_mov_b32 s49, 0
    buffer_store_dwordx4 v[4:7], v1, s[28:31], s49 offen offset:3072
    s_mov_b32 s49, 4096
    buffer_store_dwordx4 v[4:7], v1, s[28:31], s49 offen offset:0
    s_mov_b32 s49, 4096
    buffer_store_dwordx4 v[4:7], v1, s[28:31], s49 offen offset:1024
    s_mov_b32 s49, 4096
    buffer_store_dwordx4 v[4:7], v1, s[28:31], s49 offen offset:2048
    s_mov_b32 s49, 4096
    buffer_store_dwordx4 v[4:7], v1, s[28:31], s49 offen offset:3072
k12_noflags:
    s_waitcnt lgkmcnt(0)
    v_lshlrev_b32 v1, 21, v0
    s_mov_b32 s28, s16
    s_mov_b32 s29, s17
    s_mov_b32 s30, 27131904
    s_mov_b32 s31, 0x20000
    s_mov_b32 s32, s10
    s_mov_b32 s33, s11
    s_mov_b32 s34, 2621440
    s_mov_b32 s35, 0x20000
    s_lshr_b32 s33, s2, 4
    s_lshl_b32 s33, s33, 1
    s_lshr_b32 s49, s20, 2
    s_add_u32 s33, s33, s49
    s_mov_b32 s61, 1
    s_lshr_b32 s55, s20, 2
    s_lshl_b32 s55, s55, 13
    s_add_u32 s55, s55, 130912
    v_mov_b32 v14, 163684
    s_mov_b32 s68, 0x40000
k12_si:
    s_sub_u32 s68, s68, 1
    s_cbranch_scc1 k12_si_x
    ds_read_b32 v15, v14
    s_waitcnt lgkmcnt(0)
    v_readfirstlane_b32 s49, v15
    s_nop 0
    s_cmp_lt_u32 s49, 10
    s_cbranch_scc1 k12_si
k12_si_x:
    s_branch k12_rl
k12_late:
    v_lshlrev_b32 v7, 2, v0
    v_add_u32 v7, 163680, v7
    v_mov_b32 v8, 0
    s_mov_b64 exec, 0xfffff
    ds_write_b32 v7, v8
    s_mov_b64 exec, -1
    v_lshlrev_b32 v4, 1, v0
    s_lshr_b32 s50, s20, 2
    s_and_b32 s51, s20, 3
    v_and_b32 v5, 15, v0
    v_lshrrev_b32 v6, 4, v0
    v_and_b32 v7, 1, v6
    v_lshrrev_b32 v8, 1, v6
    v_lshl_add_u32 v7, v7, 1, v8
    v_lshl_add_u32 v165, v5, 2, v7
    s_mul_i32 s52, s50, 16640
    s_add_u32 s52, s52, 15456
    s_mul_i32 s53, s50, 5152
    s_lshl_b32 s49, s51, 10
    s_add_u32 s49, s49, s52
    v_lshl_add_u32 v161, v0, 4, s49
    v_mul_u32_u24 v162, 1280, v7
    v_lshl_add_u32 v162, v5, 4, v162
    s_lshl_b32 s49, s51, 8
    s_add_u32 s49, s49, s53
    v_add_u32 v162, s49, v162
    v_mul_u32_u24 v164, 1280, v6
    v_lshl_add_u32 v164, v5, 4, v164
    s_lshl_b32 s49, s51, 6
    s_sub_u32 s49, s53, s49
    s_add_u32 s49, s49, 192
    v_add_u32 v164, s49, v164
    v_bfe_u32 v7, v0, 2, 2
    v_mul_u32_u24 v7, 4160, v7
    v_and_b32 v8, 3, v0
    v_lshl_add_u32 v163, v8, 3, v7
    v_lshlrev_b32 v7, 4, v6
    v_sub_u32 v163, v163, v7
    s_lshl_b32 s49, s51, 8
    s_add_u32 s49, s49, s52
    s_add_u32 s49, s49, 56
    v_add_u32 v163, s49, v163
    s_waitcnt lgkmcnt(0)
    s_cmp_eq_u32 s61, 0
    s_cbranch_scc1 k12_nopar2
    s_mov_b32 s28, s6
    s_mov_b32 s29, s7
    s_mov_b32 s30, 245760
    s_mov_b32 s31, 0x20000
    s_mov_b32 s32, s8
    s_mov_b32 s33, s9
    s_mov_b32 s34, 245760
    s_mov_b32 s35, 0x20000
    s_mov_b32 s40, s10
    s_mov_b32 s41, s11
    s_mov_b32 s42, 245760
    s_mov_b32 s43, 0x20000
    s_mov_b32 s44, s12
    s_mov_b32 s45, s13
    s_mov_b32 s46, 245760
    s_mov_b32 s47, 0x20000
    buffer_load_ushort v152, v4, s[40:43], s36 offen offset:0 nt
    buffer_load_ushort v153, v4, s[44:47], s36 offen offset:0 nt
    buffer_load_ushort v154, v4, s[40:43], s36 offen offset:128 nt
    buffer_load_ushort v155, v4, s[44:47], s36 offen offset:128 nt
    buffer_load_ushort v156, v4, s[40:43], s36 offen offset:256 nt
    buffer_load_ushort v157, v4, s[44:47], s36 offen offset:256 nt
    buffer_load_ushort v148, v4, s[28:31], s58 offen nt
    buffer_load_ushort v149, v4, s[32:35], s58 offen nt
    buffer_load_ushort v150, v4, s[40:43], s58 offen nt
    buffer_load_ushort v151, v4, s[44:47], s58 offen nt
    s_lshr_b32 s49, s37, 1
    s_lshl_b32 s49, s49, 2
    s_load_dword s60, s[14:15], s49
    s_barrier
    s_waitcnt vmcnt(0) lgkmcnt(0)
    s_branch k12_gen
k12_nopar2:
    s_barrier
k12_now:
    s_mov_b32 s24, s16
    s_mov_b32 s25, s17
    s_mov_b32 s26, 5242880
    s_mov_b32 s27, 0x20000
    s_branch k12_gsetup
k12_rl:
    s_cmp_ge_u32 s33, 90
    s_cbranch_scc1 k12_conv
    s_load_dwordx4 s[64:67], s[0:1], 64
    s_load_dwordx2 s[12:13], s[0:1], 80
    s_waitcnt vmcnt(0) lgkmcnt(0)
    s_cmp_ge_u32 s33, 60
    s_cbranch_scc1 k12_rl2
    s_bfe_u32 s23, s2, 0x20001
    s_mul_i32 s23, s23, 60
    s_add_u32 s33, s33, s23
    s_cmp_ge_u32 s33, 120
    s_cselect_b32 s36, 1, 0
    s_mul_i32 s23, s36, 120
    s_sub_u32 s33, s33, s23
    s_mul_i32 s37, s33, 43
    s_lshr_b32 s37, s37, 9
    s_mul_i32 s23, s37, 12
    s_sub_u32 s33, s33, s23
    s_and_b32 s23, s2, 1
    s_mul_i32 s23, s23, 12
    s_add_u32 s38, s33, s23
    s_cmp_eq_u32 s36, 0
    s_cselect_b32 s24, s64, s66
    s_cselect_b32 s25, s65, s67
    s_mov_b32 s26, 1966080
    s_mov_b32 s27, 0x20000
    s_mul_i32 s39, s37, 196608
    s_lshl_b32 s23, s38, 7
    s_add_u32 s39, s39, s23
    s_lshl_b32 s41, s37, 1
    s_add_u32 s41, s41, s36
    s_mul_i32 s41, s41, 6144
    s_lshl_b32 s23, s38, 8
    s_add_u32 s41, s41, s23
    s_mul_i32 s42, s37, 192
    s_lshl_b32 s23, s38, 2
    s_add_u32 s42, s42, s23
    s_lshl_b32 s42, s42, 1
    s_add_u32 s42, s42, s36
    s_lshl_b32 s42, s42, 10
    v_bfe_u32 v5, v0, 1, 3
    v_mul_u32_u24 v4, 3072, v5
    v_and_b32 v5, 1, v0
    v_lshl_add_u32 v4, v5, 4, v4
    v_lshrrev_b32 v5, 4, v0
    v_lshl_add_u32 v4, v5, 5, v4
    s_add_u32 m0, s55, 0
    s_nop 0
    buffer_load_dwordx4 v4, s[24:27], s39 offen nt lds
    s_add_u32 s39, s39, 24576
    s_add_u32 m0, s55, 1024
    s_nop 0
    buffer_load_dwordx4 v4, s[24:27], s39 offen nt lds
    s_add_u32 s39, s39, 24576
    s_add_u32 m0, s55, 2048
    s_nop 0
    buffer_load_dwordx4 v4, s[24:27], s39 offen nt lds
    s_add_u32 s39, s39, 24576
    s_add_u32 m0, s55, 3072
    s_nop 0
    buffer_load_dwordx4 v4, s[24:27], s39 offen nt lds
    s_add_u32 s39, s39, 24576
    s_add_u32 m0, s55, 4096
    s_nop 0
    buffer_load_dwordx4 v4, s[24:27], s39 offen nt lds
    s_add_u32 s39, s39, 24576
    s_add_u32 m0, s55, 5120
    s_nop 0
    buffer_load_dwordx4 v4, s[24:27], s39 offen nt lds
    s_add_u32 s39, s39, 24576
    s_add_u32 m0, s55, 6144
    s_nop 0
    buffer_load_dwordx4 v4, s[24:27], s39 offen nt lds
    s_add_u32 s39, s39, 24576
    s_add_u32 m0, s55, 7168
    s_nop 0
    buffer_load_dwordx4 v4, s[24:27], s39 offen nt lds
    s_add_u32 s39, s39, 24576
    s_add_u32 s28, s16, 20971520
    s_addc_u32 s29, s17, 0
    s_mov_b32 s30, 3932160
    s_mov_b32 s31, 0x20000
    s_add_u32 s64, s16, 18874368
    s_addc_u32 s65, s17, 0
    s_mov_b32 s66, 122880
    s_mov_b32 s67, 0x20000
    s_cmp_eq_u32 s61, 0
    s_cbranch_scc1 k12_emit
    s_mov_b32 s70, s41
    s_mov_b32 s71, s42
    s_mov_b32 s72, s55
    s_mov_b32 s69, 1
    s_branch k12_conv
    v_mov_b32 v14, 163740
    s_mov_b32 s68, 0x40000
k12_se:
    s_sub_u32 s68, s68, 1
    s_cbranch_scc1 k12_se_x
    ds_read_b32 v15, v14
    s_waitcnt lgkmcnt(0)
    v_readfirstlane_b32 s49, v15
    s_nop 0
    s_cmp_lt_u32 s49, 1
    s_cbranch_scc1 k12_se
k12_se_x:
k12_emit:
    s_waitcnt vmcnt(0)
    v_lshrrev_b32 v1, 4, v0
    v_bfe_u32 v2, v0, 2, 2
    v_bfe_u32 v3, v0, 4, 1
    v_lshl_add_u32 v2, v3, 2, v2
    v_and_b32 v3, 3, v0
    v_lshrrev_b32 v5, 1, v1
    v_lshlrev_b32 v5, 11, v5
    v_lshl_add_u32 v5, v2, 5, v5
    v_lshl_add_u32 v5, v3, 3, v5
    v_add_u32 v5, s55, v5
    v_lshlrev_b32 v6, 4, v0
    ds_read_b64_tr_b16 v[16:17], v5 offset:0
    ds_read_b64_tr_b16 v[18:19], v5 offset:1024
    ds_read_b64_tr_b16 v[20:21], v5 offset:256
    ds_read_b64_tr_b16 v[22:23], v5 offset:1280
    ds_read_b64_tr_b16 v[24:25], v5 offset:512
    ds_read_b64_tr_b16 v[26:27], v5 offset:1536
    ds_read_b64_tr_b16 v[28:29], v5 offset:768
    ds_read_b64_tr_b16 v[30:31], v5 offset:1792
    ds_read_b64_tr_b16 v[32:33], v5 offset:4096
    ds_read_b64_tr_b16 v[34:35], v5 offset:5120
    ds_read_b64_tr_b16 v[36:37], v5 offset:4352
    ds_read_b64_tr_b16 v[38:39], v5 offset:5376
    ds_read_b64_tr_b16 v[40:41], v5 offset:4608
    ds_read_b64_tr_b16 v[42:43], v5 offset:5632
    ds_read_b64_tr_b16 v[44:45], v5 offset:4864
    ds_read_b64_tr_b16 v[46:47], v5 offset:5888
    s_add_u32 s40, s42, 0
    s_waitcnt lgkmcnt(14)
    buffer_store_dwordx4 v[16:19], v6, s[28:31], s40 offen sc1
    s_add_u32 s40, s42, 2048
    s_waitcnt lgkmcnt(12)
    buffer_store_dwordx4 v[20:23], v6, s[28:31], s40 offen sc1
    s_add_u32 s40, s42, 4096
    s_waitcnt lgkmcnt(10)
    buffer_store_dwordx4 v[24:27], v6, s[28:31], s40 offen sc1
    s_add_u32 s40, s42, 6144
    s_waitcnt lgkmcnt(8)
    buffer_store_dwordx4 v[28:31], v6, s[28:31], s40 offen sc1
    s_add_u32 s40, s42, 196608
    s_waitcnt lgkmcnt(6)
    buffer_store_dwordx4 v[32:35], v6, s[28:31], s40 offen sc1
    s_add_u32 s40, s42, 198656
    s_waitcnt lgkmcnt(4)
    buffer_store_dwordx4 v[36:39], v6, s[28:31], s40 offen sc1
    s_add_u32 s40, s42, 200704
    s_waitcnt lgkmcnt(2)
    buffer_store_dwordx4 v[40:43], v6, s[28:31], s40 offen sc1
    s_add_u32 s40, s42, 202752
    s_waitcnt lgkmcnt(0)
    buffer_store_dwordx4 v[44:47], v6, s[28:31], s40 offen sc1
    s_mov_b32 s46, 0x3f803f80
    v_dot2_f32_bf16 v8, v16, s46, 0
    v_dot2_f32_bf16 v9, v20, s46, 0
    v_dot2_f32_bf16 v10, v24, s46, 0
    v_dot2_f32_bf16 v11, v28, s46, 0
    v_dot2_f32_bf16 v8, v17, s46, v8
    v_dot2_f32_bf16 v9, v21, s46, v9
    v_dot2_f32_bf16 v10, v25, s46, v10
    v_dot2_f32_bf16 v11, v29, s46, v11
    v_dot2_f32_bf16 v8, v18, s46, v8
    v_dot2_f32_bf16 v9, v22, s46, v9
    v_dot2_f32_bf16 v10, v26, s46, v10
    v_dot2_f32_bf16 v11, v30, s46, v11
    v_dot2_f32_bf16 v8, v19, s46, v8
    v_dot2_f32_bf16 v9, v23, s46, v9
    v_dot2_f32_bf16 v10, v27, s46, v10
    v_dot2_f32_bf16 v11, v31, s46, v11
    v_dot2_f32_bf16 v8, v32, s46, v8
    v_dot2_f32_bf16 v9, v36, s46, v9
    v_dot2_f32_bf16 v10, v40, s46, v10
    v_dot2_f32_bf16 v11, v44, s46, v11
    v_dot2_f32_bf16 v8, v33, s46, v8
    v_dot2_f32_bf16 v9, v37, s46, v9
    v_dot2_f32_bf16 v10, v41, s46, v10
    v_dot2_f32_bf16 v11, v45, s46, v11
    v_dot2_f32_bf16 v8, v34, s46, v8
    v_dot2_f32_bf16 v9, v38, s46, v9
    v_dot2_f32_bf16 v10, v42, s46, v10
    v_dot2_f32_bf16 v11, v46, s46, v11
    v_dot2_f32_bf16 v8, v35, s46, v8
    v_dot2_f32_bf16 v9, v39, s46, v9
    v_dot2_f32_bf16 v10, v43, s46, v10
    v_dot2_f32_bf16 v11, v47, s46, v11
    v_mov_b32 v12, v8
    v_mov_b32 v13, v9
    v_mov_b32 v14, v10
    v_mov_b32 v15, v11
    v_permlane16_swap_b32 v8, v12
    v_permlane16_swap_b32 v9, v13
    v_permlane16_swap_b32 v10, v14
    v_permlane16_swap_b32 v11, v15
    v_add_f32 v8, v8, v12
    v_add_f32 v9, v9, v13
    v_add_f32 v10, v10, v14
    v_add_f32 v11, v11, v15
    v_mov_b32 v12, v8
    v_mov_b32 v13, v9
    v_mov_b32 v14, v10
    v_mov_b32 v15, v11
    v_permlane32_swap_b32 v8, v12
    v_permlane32_swap_b32 v9, v13
    v_permlane32_swap_b32 v10, v14
    v_permlane32_swap_b32 v11, v15
    v_add_f32 v8, v8, v12
    v_add_f32 v9, v9, v13
    v_add_f32 v10, v10, v14
    v_add_f32 v11, v11, v15
    v_cmp_eq_u32 vcc, 1, v1
    s_nop 1
    v_cndmask_b32 v8, v8, v9, vcc
    v_cmp_eq_u32 vcc, 2, v1
    s_nop 1
    v_cndmask_b32 v8, v8, v10, vcc
    v_cmp_eq_u32 vcc, 3, v1
    s_nop 1
    v_cndmask_b32 v8, v8, v11, vcc
    v_lshlrev_b32 v6, 2, v0
    buffer_store_dword v8, v6, s[64:67], s41 offen
    s_branch k12_conv
k12_rl2:
    s_sub_u32 s33, s33, 60
    s_mov_b32 s44, s12
    s_mov_b32 s45, s13
    s_mov_b32 s46, 1966080
    s_mov_b32 s47, 0x20000
    s_bfe_u32 s23, s2, 0x20001
    s_mul_i32 s23, s23, 30
    s_add_u32 s33, s33, s23
    s_mul_i32 s37, s33, 205
    s_lshr_b32 s37, s37, 10
    s_mul_i32 s23, s37, 5
    s_sub_u32 s33, s33, s23
    s_and_b32 s23, s2, 1
    s_mul_i32 s23, s23, 5
    s_add_u32 s38, s33, s23
    s_mul_i32 s39, s37, 81920
    s_lshl_b32 s23, s38, 7
    s_add_u32 s39, s39, s23
    s_mul_i32 s52, s37, 80
    s_lshl_b32 s23, s38, 2
    s_add_u32 s52, s52, s23
    s_lshl_b32 s52, s52, 10
    v_bfe_u32 v5, v0, 1, 3
    v_mul_u32_u24 v4, 1280, v5
    v_and_b32 v5, 1, v0
    v_lshl_add_u32 v4, v5, 4, v4
    v_lshrrev_b32 v5, 4, v0
    v_lshl_add_u32 v4, v5, 5, v4
    s_add_u32 m0, s55, 0
    s_nop 0
    buffer_load_dwordx4 v4, s[44:47], s39 offen nt lds
    s_add_u32 s39, s39, 10240
    s_add_u32 m0, s55, 1024
    s_nop 0
    buffer_load_dwordx4 v4, s[44:47], s39 offen nt lds
    s_add_u32 s39, s39, 10240
    s_add_u32 m0, s55, 2048
    s_nop 0
    buffer_load_dwordx4 v4, s[44:47], s39 offen nt lds
    s_add_u32 s39, s39, 10240
    s_add_u32 m0, s55, 3072
    s_nop 0
    buffer_load_dwordx4 v4, s[44:47], s39 offen nt lds
    s_add_u32 s39, s39, 10240
    s_add_u32 m0, s55, 4096
    s_nop 0
    buffer_load_dwordx4 v4, s[44:47], s39 offen nt lds
    s_add_u32 s39, s39, 10240
    s_add_u32 m0, s55, 5120
    s_nop 0
    buffer_load_dwordx4 v4, s[44:47], s39 offen nt lds
    s_add_u32 s39, s39, 10240
    s_add_u32 m0, s55, 6144
    s_nop 0
    buffer_load_dwordx4 v4, s[44:47], s39 offen nt lds
    s_add_u32 s39, s39, 10240
    s_add_u32 m0, s55, 7168
    s_nop 0
    buffer_load_dwordx4 v4, s[44:47], s39 offen nt lds
    s_add_u32 s39, s39, 10240
    s_add_u32 s28, s16, 25165824
    s_addc_u32 s29, s17, 0
    s_mov_b32 s30, 1966080
    s_mov_b32 s31, 0x20000
    s_waitcnt vmcnt(0)
    v_lshrrev_b32 v1, 4, v0
    v_bfe_u32 v2, v0, 2, 2
    v_bfe_u32 v3, v0, 4, 1
    v_lshl_add_u32 v2, v3, 2, v2
    v_and_b32 v3, 3, v0
    v_lshrrev_b32 v5, 1, v1
    v_lshlrev_b32 v5, 10, v5
    v_lshl_add_u32 v5, v2, 5, v5
    v_lshl_add_u32 v5, v3, 3, v5
    v_add_u32 v5, s55, v5
    v_lshlrev_b32 v6, 4, v0
    ds_read_b64_tr_b16 v[16:17], v5 offset:0
    ds_read_b64_tr_b16 v[18:19], v5 offset:2048
    ds_read_b64_tr_b16 v[20:21], v5 offset:256
    ds_read_b64_tr_b16 v[22:23], v5 offset:2304
    ds_read_b64_tr_b16 v[24:25], v5 offset:512
    ds_read_b64_tr_b16 v[26:27], v5 offset:2560
    ds_read_b64_tr_b16 v[28:29], v5 offset:768
    ds_read_b64_tr_b16 v[30:31], v5 offset:2816
    ds_read_b64_tr_b16 v[32:33], v5 offset:4096
    ds_read_b64_tr_b16 v[34:35], v5 offset:6144
    ds_read_b64_tr_b16 v[36:37], v5 offset:4352
    ds_read_b64_tr_b16 v[38:39], v5 offset:6400
    ds_read_b64_tr_b16 v[40:41], v5 offset:4608
    ds_read_b64_tr_b16 v[42:43], v5 offset:6656
    ds_read_b64_tr_b16 v[44:45], v5 offset:4864
    ds_read_b64_tr_b16 v[46:47], v5 offset:6912
    s_add_u32 s40, s52, 0
    s_waitcnt lgkmcnt(14)
    buffer_store_dwordx4 v[16:19], v6, s[28:31], s40 offen sc1
    s_add_u32 s40, s52, 1024
    s_waitcnt lgkmcnt(12)
    buffer_store_dwordx4 v[20:23], v6, s[28:31], s40 offen sc1
    s_add_u32 s40, s52, 2048
    s_waitcnt lgkmcnt(10)
    buffer_store_dwordx4 v[24:27], v6, s[28:31], s40 offen sc1
    s_add_u32 s40, s52, 3072
    s_waitcnt lgkmcnt(8)
    buffer_store_dwordx4 v[28:31], v6, s[28:31], s40 offen sc1
    s_add_u32 s40, s52, 40960
    s_waitcnt lgkmcnt(6)
    buffer_store_dwordx4 v[32:35], v6, s[28:31], s40 offen sc1
    s_add_u32 s40, s52, 41984
    s_waitcnt lgkmcnt(4)
    buffer_store_dwordx4 v[36:39], v6, s[28:31], s40 offen sc1
    s_add_u32 s40, s52, 43008
    s_waitcnt lgkmcnt(2)
    buffer_store_dwordx4 v[40:43], v6, s[28:31], s40 offen sc1
    s_add_u32 s40, s52, 44032
    s_waitcnt lgkmcnt(0)
    buffer_store_dwordx4 v[44:47], v6, s[28:31], s40 offen sc1
    s_branch k12_fin
k12_conv:
    s_lshr_b32 s56, s20, 2
    s_and_b32 s57, s20, 3
    s_cmp_ge_u32 s56, s22
    s_cbranch_scc1 k12_fin
    s_add_u32 s21, s21, s56
    s_setprio 2
    s_waitcnt vmcnt(0) lgkmcnt(0)
    s_mov_b32 s28, s62
    s_mov_b32 s29, s63
    s_mov_b32 s30, 1280
    s_mov_b32 s31, 0x20000
    s_lshl_b32 s49, s21, 1
    buffer_load_ushort v5, off, s[28:31], s49
    s_add_u32 s24, s16, 2621440
    s_addc_u32 s25, s17, 0
    s_mov_b32 s26, 2621440
    s_mov_b32 s27, 0x20000
    s_add_u32 s40, s16, 8388608
    s_addc_u32 s41, s17, 0
    s_mov_b32 s42, 2621440
    s_mov_b32 s43, 0x20000
    s_mov_b32 s51, 0x00003f80
    s_mov_b32 s52, 0x3f800000
    v_mov_b32 v9, v161
    v_mov_b32 v10, v162
    v_mov_b32 v11, v163
    v_mov_b32 v12, v164
    v_mov_b32 v6, v165
    v_lshlrev_b32 v8, 4, v0
    s_lshl_b32 s33, s56, 2
    s_add_u32 s34, s33, 163700
    s_add_u32 s35, s33, 163716
    s_add_u32 s36, s33, 163728
    s_add_u32 s37, s33, 163760
    v_mul_u32_u24 v13, 10240, v6
    s_mul_i32 s23, s57, 655360
    s_lshl_b32 s49, s21, 4
    s_add_u32 s23, s23, s49
    s_setprio 2
    v_mov_b32 v14, s34
    s_mov_b32 s68, 0x40000
k12_s6:
    s_sub_u32 s68, s68, 1
    s_cbranch_scc1 k12_s6_x
    ds_read_b32 v15, v14
    s_waitcnt lgkmcnt(0)
    v_readfirstlane_b32 s49, v15
    s_nop 0
    s_cmp_lt_u32 s49, 1
    s_cbranch_scc1 k12_s6
k12_s6_x:
    s_setprio 2
    ds_read_b64 v[16:17], v9 offset:56
    ds_read_b128 v[18:21], v9 offset:64
    v_mov_b32 v7, s37
    ds_read_b32 v2, v7
    s_waitcnt lgkmcnt(1)
    v_alignbit_b32 v36, v18, v17, 16
    v_alignbit_b32 v37, v19, v18, 16
    v_alignbit_b32 v38, v20, v19, 16
    v_alignbit_b32 v39, v21, v20, 16
    ds_write_b128 v9, v[36:39] offset:4224
    v_mov_b32 v40, v17
    v_mov_b32 v41, v18
    v_mov_b32 v42, v19
    v_mov_b32 v43, v20
    ds_write_b128 v9, v[40:43] offset:8384
    v_alignbit_b32 v44, v17, v16, 16
    v_alignbit_b32 v45, v18, v17, 16
    v_alignbit_b32 v46, v19, v18, 16
    v_alignbit_b32 v47, v20, v19, 16
    ds_write_b128 v9, v[44:47] offset:12544
    v_mov_b32 v14, s35
    v_mov_b32 v15, 1
    s_mov_b64 exec, 1
    ds_add_u32 v14, v15
    s_mov_b64 exec, -1
    s_setprio 2
    s_mul_i32 s49, s56, 32768
    s_lshl_b32 s50, s57, 11
    s_add_u32 s49, s49, s50
    s_add_u32 s49, s49, 65376
    v_add_u32 v9, s49, v8
    s_mul_i32 s50, s57, 6144
    v_add_u32 v8, s50, v9
    v_mov_b32 v14, s35
    s_waitcnt lgkmcnt(0)
    s_mov_b32 s68, 0x40000
k12_s8:
    s_sub_u32 s68, s68, 1
    s_cbranch_scc1 k12_s8_x
    ds_read_b32 v15, v14
    s_waitcnt lgkmcnt(0)
    v_readfirstlane_b32 s49, v15
    s_nop 0
    s_cmp_lt_u32 s49, 4
    s_cbranch_scc1 k12_s8
k12_s8_x:
    v_mov_b32 v14, 163712
    s_mov_b32 s68, 0x40000
k12_s7:
    s_sub_u32 s68, s68, 1
    s_cbranch_scc1 k12_s7_x
    ds_read_b32 v15, v14
    s_waitcnt lgkmcnt(0)
    v_readfirstlane_b32 s49, v15
    s_nop 0
    s_cmp_lt_u32 s49, 3
    s_cbranch_scc1 k12_s7
k12_s7_x:
    s_add_u32 s49, s56, 1
    s_cmp_lg_u32 s49, s22
    s_cselect_b32 s38, 1, 0
    s_cbranch_scc1 k12_xl1
    buffer_load_dwordx4 v[164:167], v13, s[24:27], s23 offen sc1
k12_xl1:
    ds_read_b128 v[160:163], v10 offset:256
    s_setprio 1
    ds_read_b128 v[48:51], v12 offset:64
    ds_read_b64_tr_b16 v[16:17], v11 offset:8
    ds_read_b64_tr_b16 v[18:19], v11 offset:0
    ds_read_b64_tr_b16 v[20:21], v11 offset:40
    ds_read_b64_tr_b16 v[22:23], v11 offset:32
    ds_read_b128 v[52:55], v12 offset:320
    ds_read_b128 v[56:59], v12 offset:576
    ds_read_b128 v[60:63], v12 offset:832
    ds_read_b64_tr_b16 v[24:25], v11 offset:1032
    ds_read_b64_tr_b16 v[26:27], v11 offset:1024
    ds_read_b64_tr_b16 v[28:29], v11 offset:1064
    ds_read_b64_tr_b16 v[30:31], v11 offset:1056
    ds_read_b64_tr_b16 v[32:33], v11 offset:2056
    ds_read_b64_tr_b16 v[34:35], v11 offset:2048
    ds_read_b64_tr_b16 v[36:37], v11 offset:2088
    ds_read_b64_tr_b16 v[38:39], v11 offset:2080
    ds_read_b64_tr_b16 v[40:41], v11 offset:3080
    ds_read_b64_tr_b16 v[42:43], v11 offset:3072
    ds_read_b64_tr_b16 v[44:45], v11 offset:3112
    ds_read_b64_tr_b16 v[46:47], v11 offset:3104
    s_waitcnt vmcnt(1)
    s_cmp_eq_u32 s38, 0
    s_cbranch_scc1 k12_dok
    s_waitcnt vmcnt(0)
k12_dok:
    s_waitcnt lgkmcnt(15)
    v_mfma_f32_16x16x32_f16 v[128:131], v[16:19], v[48:51], 0
    ds_read_b128 v[96:99], v12 offset:48
    v_mfma_f32_16x16x32_f16 v[132:135], v[20:23], v[48:51], 0
    ds_read_b64_tr_b16 v[64:65], v11 offset:72
    s_waitcnt lgkmcnt(15)
    v_mfma_f32_16x16x32_f16 v[136:139], v[16:19], v[52:55], 0
    ds_read_b64_tr_b16 v[66:67], v11 offset:64
    v_mfma_f32_16x16x32_f16 v[140:143], v[20:23], v[52:55], 0
    ds_read_b64_tr_b16 v[68:69], v11 offset:104
    v_mfma_f32_16x16x32_f16 v[144:147], v[16:19], v[56:59], 0
    ds_read_b64_tr_b16 v[70:71], v11 offset:96
    v_mfma_f32_16x16x32_f16 v[148:151], v[20:23], v[56:59], 0
    ds_read_b128 v[100:103], v12 offset:304
    s_waitcnt lgkmcnt(15)
    v_mfma_f32_16x16x32_f16 v[152:155], v[16:19], v[60:63], 0
    ds_read_b128 v[104:107], v12 offset:560
    v_mfma_f32_16x16x32_f16 v[156:159], v[20:23], v[60:63], 0
    ds_read_b128 v[108:111], v12 offset:816
    v_mfma_f32_16x16x32_f16 v[136:139], v[24:27], v[48:51], v[136:139]
    ds_read_b64_tr_b16 v[72:73], v11 offset:1096
    s_waitcnt lgkmcnt(15)
    v_mfma_f32_16x16x32_f16 v[140:143], v[28:31], v[48:51], v[140:143]
    ds_read_b64_tr_b16 v[74:75], v11 offset:1088
    v_mfma_f32_16x16x32_f16 v[144:147], v[24:27], v[52:55], v[144:147]
    ds_read_b64_tr_b16 v[76:77], v11 offset:1128
    v_mfma_f32_16x16x32_f16 v[148:151], v[28:31], v[52:55], v[148:151]
    ds_read_b64_tr_b16 v[78:79], v11 offset:1120
    v_mfma_f32_16x16x32_f16 v[152:155], v[24:27], v[56:59], v[152:155]
    ds_read_b64_tr_b16 v[80:81], v11 offset:2120
    v_cvt_f32_f16 v112, v160
    v_mfma_f32_16x16x32_f16 v[156:159], v[28:31], v[56:59], v[156:159]
    ds_read_b64_tr_b16 v[82:83], v11 offset:2112
    v_lshrrev_b32 v160, 16, v160
    v_mfma_f32_16x16x32_f16 v[144:147], v[32:35], v[48:51], v[144:147]
    ds_read_b64_tr_b16 v[84:85], v11 offset:2152
    s_waitcnt lgkmcnt(15)
    v_mfma_f32_16x16x32_f16 v[148:151], v[36:39], v[48:51], v[148:151]
    ds_read_b64_tr_b16 v[86:87], v11 offset:2144
    v_cvt_f32_f16 v113, v160
    v_mfma_f32_16x16x32_f16 v[152:155], v[32:35], v[52:55], v[152:155]
    ds_read_b64_tr_b16 v[88:89], v11 offset:3144
    v_cvt_f32_f16 v114, v161
    v_mfma_f32_16x16x32_f16 v[156:159], v[36:39], v[52:55], v[156:159]
    ds_read_b64_tr_b16 v[90:91], v11 offset:3136
    v_lshrrev_b32 v161, 16, v161
    v_mfma_f32_16x16x32_f16 v[152:155], v[40:43], v[48:51], v[152:155]
    ds_read_b64_tr_b16 v[92:93], v11 offset:3176
    v_cvt_f32_f16 v115, v161
    v_mfma_f32_16x16x32_f16 v[156:159], v[44:47], v[48:51], v[156:159]
    ds_read_b64_tr_b16 v[94:95], v11 offset:3168
    s_waitcnt lgkmcnt(15)
    v_mfma_f32_16x16x32_f16 v[128:131], v[64:67], v[96:99], v[128:131]
    ds_read_b128 v[48:51], v12 offset:32
    v_cvt_f32_f16 v116, v162
    v_mfma_f32_16x16x32_f16 v[132:135], v[68:71], v[96:99], v[132:135]
    ds_read_b64_tr_b16 v[16:17], v11 offset:136
    s_waitcnt lgkmcnt(15)
    v_mfma_f32_16x16x32_f16 v[136:139], v[64:67], v[100:103], v[136:139]
    ds_read_b64_tr_b16 v[18:19], v11 offset:128
    v_lshrrev_b32 v162, 16, v162
    v_mfma_f32_16x16x32_f16 v[140:143], v[68:71], v[100:103], v[140:143]
    ds_read_b64_tr_b16 v[20:21], v11 offset:168
    v_cvt_f32_f16 v117, v162
    v_mfma_f32_16x16x32_f16 v[144:147], v[64:67], v[104:107], v[144:147]
    ds_read_b64_tr_b16 v[22:23], v11 offset:160
    v_cvt_f32_f16 v118, v163
    v_mfma_f32_16x16x32_f16 v[148:151], v[68:71], v[104:107], v[148:151]
    ds_read_b128 v[52:55], v12 offset:288
    s_waitcnt lgkmcnt(15)
    v_mfma_f32_16x16x32_f16 v[152:155], v[64:67], v[108:111], v[152:155]
    ds_read_b128 v[56:59], v12 offset:544
    v_lshrrev_b32 v163, 16, v163
    v_mfma_f32_16x16x32_f16 v[156:159], v[68:71], v[108:111], v[156:159]
    ds_read_b128 v[60:63], v12 offset:800
    v_cvt_f32_f16 v119, v163
    v_mfma_f32_16x16x32_f16 v[136:139], v[72:75], v[96:99], v[136:139]
    ds_read_b64_tr_b16 v[24:25], v11 offset:1160
    s_waitcnt lgkmcnt(15)
    v_mfma_f32_16x16x32_f16 v[140:143], v[76:79], v[96:99], v[140:143]
    ds_read_b64_tr_b16 v[26:27], v11 offset:1152
    v_lshlrev_b32 v5, 16, v5
    v_mfma_f32_16x16x32_f16 v[144:147], v[72:75], v[100:103], v[144:147]
    ds_read_b64_tr_b16 v[28:29], v11 offset:1192
    v_mul_f32 v112, v5, v112
    v_mfma_f32_16x16x32_f16 v[148:151], v[76:79], v[100:103], v[148:151]
    ds_read_b64_tr_b16 v[30:31], v11 offset:1184
    v_mul_f32 v113, v5, v113
    v_mfma_f32_16x16x32_f16 v[152:155], v[72:75], v[104:107], v[152:155]
    ds_read_b64_tr_b16 v[32:33], v11 offset:2184
    v_mul_f32 v114, v5, v114
    v_mfma_f32_16x16x32_f16 v[156:159], v[76:79], v[104:107], v[156:159]
    ds_read_b64_tr_b16 v[34:35], v11 offset:2176
    v_mul_f32 v115, v5, v115
    v_mfma_f32_16x16x32_f16 v[144:147], v[80:83], v[96:99], v[144:147]
    ds_read_b64_tr_b16 v[36:37], v11 offset:2216
    s_waitcnt lgkmcnt(15)
    v_mfma_f32_16x16x32_f16 v[148:151], v[84:87], v[96:99], v[148:151]
    ds_read_b64_tr_b16 v[38:39], v11 offset:2208
    v_mul_f32 v116, v5, v116
    v_mfma_f32_16x16x32_f16 v[152:155], v[80:83], v[100:103], v[152:155]
    ds_read_b64_tr_b16 v[40:41], v11 offset:3208
    v_mul_f32 v117, v5, v117
    v_mfma_f32_16x16x32_f16 v[156:159], v[84:87], v[100:103], v[156:159]
    ds_read_b64_tr_b16 v[42:43], v11 offset:3200
    v_mul_f32 v118, v5, v118
    v_mfma_f32_16x16x32_f16 v[152:155], v[88:91], v[96:99], v[152:155]
    ds_read_b64_tr_b16 v[44:45], v11 offset:3240
    v_mul_f32 v119, v5, v119
    v_mfma_f32_16x16x32_f16 v[156:159], v[92:95], v[96:99], v[156:159]
    ds_read_b64_tr_b16 v[46:47], v11 offset:3232
    s_waitcnt lgkmcnt(15)
    v_mfma_f32_16x16x32_f16 v[128:131], v[16:19], v[48:51], v[128:131]
    ds_read_b128 v[96:99], v12 offset:16
    v_cvt_pk_bf16_f32 v160, v112, v113
    v_mfma_f32_16x16x32_f16 v[132:135], v[20:23], v[48:51], v[132:135]
    ds_read_b64_tr_b16 v[64:65], v11 offset:200
    s_waitcnt lgkmcnt(15)
    v_mfma_f32_16x16x32_f16 v[136:139], v[16:19], v[52:55], v[136:139]
    ds_read_b64_tr_b16 v[66:67], v11 offset:192
    v_cvt_pk_bf16_f32 v161, v114, v115
    v_mfma_f32_16x16x32_f16 v[140:143], v[20:23], v[52:55], v[140:143]
    ds_read_b64_tr_b16 v[68:69], v11 offset:232
    v_cvt_pk_bf16_f32 v162, v116, v117
    v_mfma_f32_16x16x32_f16 v[144:147], v[16:19], v[56:59], v[144:147]
    ds_read_b64_tr_b16 v[70:71], v11 offset:224
    v_cvt_pk_bf16_f32 v163, v118, v119
    v_mfma_f32_16x16x32_f16 v[148:151], v[20:23], v[56:59], v[148:151]
    ds_read_b128 v[100:103], v12 offset:272
    s_waitcnt lgkmcnt(15)
    v_mfma_f32_16x16x32_f16 v[152:155], v[16:19], v[60:63], v[152:155]
    ds_read_b128 v[104:107], v12 offset:528
    v_lshlrev_b32 v112, 16, v160
    v_mfma_f32_16x16x32_f16 v[156:159], v[20:23], v[60:63], v[156:159]
    ds_read_b128 v[108:111], v12 offset:784
    v_and_b32 v113, s48, v160
    v_mfma_f32_16x16x32_f16 v[136:139], v[24:27], v[48:51], v[136:139]
    ds_read_b64_tr_b16 v[72:73], v11 offset:1224
    s_waitcnt lgkmcnt(15)
    v_mfma_f32_16x16x32_f16 v[140:143], v[28:31], v[48:51], v[140:143]
    ds_read_b64_tr_b16 v[74:75], v11 offset:1216
    v_lshlrev_b32 v114, 16, v161
    v_mfma_f32_16x16x32_f16 v[144:147], v[24:27], v[52:55], v[144:147]
    ds_read_b64_tr_b16 v[76:77], v11 offset:1256
    v_and_b32 v115, s48, v161
    v_mfma_f32_16x16x32_f16 v[148:151], v[28:31], v[52:55], v[148:151]
    ds_read_b64_tr_b16 v[78:79], v11 offset:1248
    v_lshlrev_b32 v116, 16, v162
    v_mfma_f32_16x16x32_f16 v[152:155], v[24:27], v[56:59], v[152:155]
    ds_read_b64_tr_b16 v[80:81], v11 offset:2248
    v_and_b32 v117, s48, v162
    v_mfma_f32_16x16x32_f16 v[156:159], v[28:31], v[56:59], v[156:159]
    ds_read_b64_tr_b16 v[82:83], v11 offset:2240
    v_lshlrev_b32 v118, 16, v163
    v_mfma_f32_16x16x32_f16 v[144:147], v[32:35], v[48:51], v[144:147]
    ds_read_b64_tr_b16 v[84:85], v11 offset:2280
    s_waitcnt lgkmcnt(15)
    v_mfma_f32_16x16x32_f16 v[148:151], v[36:39], v[48:51], v[148:151]
    ds_read_b64_tr_b16 v[86:87], v11 offset:2272
    v_and_b32 v119, s48, v163
    v_mfma_f32_16x16x32_f16 v[152:155], v[32:35], v[52:55], v[152:155]
    ds_read_b64_tr_b16 v[88:89], v11 offset:3272
    v_mfma_f32_16x16x32_f16 v[156:159], v[36:39], v[52:55], v[156:159]
    ds_read_b64_tr_b16 v[90:91], v11 offset:3264
    v_mfma_f32_16x16x32_f16 v[152:155], v[40:43], v[48:51], v[152:155]
    ds_read_b64_tr_b16 v[92:93], v11 offset:3304
    v_mfma_f32_16x16x32_f16 v[156:159], v[44:47], v[48:51], v[156:159]
    ds_read_b64_tr_b16 v[94:95], v11 offset:3296
    s_cmp_eq_u32 s38, 0
    s_cbranch_scc1 k12_nog
    s_add_u32 s34, s34, 4
    s_cmp_eq_u32 s38, 0
    s_cselect_b32 s34, 163716, s34
    s_cselect_b32 s39, 4, 1
    v_mov_b32 v14, s34
    s_waitcnt lgkmcnt(0)
    s_mov_b32 s68, 0x40000
k12_sq:
    s_sub_u32 s68, s68, 1
    s_cbranch_scc1 k12_sq_x
    ds_read_b32 v15, v14
    s_waitcnt lgkmcnt(0)
    v_readfirstlane_b32 s49, v15
    s_nop 0
    s_cmp_lt_u32 s49, s39
    s_cbranch_scc1 k12_sq
k12_sq_x:
k12_nog:
    s_waitcnt lgkmcnt(15)
    v_mfma_f32_16x16x32_f16 v[128:131], v[64:67], v[96:99], v[128:131]
    v_mfma_f32_16x16x32_f16 v[132:135], v[68:71], v[96:99], v[132:135]
    s_waitcnt lgkmcnt(14)
    v_mfma_f32_16x16x32_f16 v[136:139], v[64:67], v[100:103], v[136:139]
    v_mfma_f32_16x16x32_f16 v[140:143], v[68:71], v[100:103], v[140:143]
    s_waitcnt lgkmcnt(13)
    v_mfma_f32_16x16x32_f16 v[144:147], v[64:67], v[104:107], v[144:147]
    v_mfma_f32_16x16x32_f16 v[148:151], v[68:71], v[104:107], v[148:151]
    s_waitcnt lgkmcnt(12)
    v_mfma_f32_16x16x32_f16 v[152:155], v[64:67], v[108:111], v[152:155]
    ds_write_b128 v9, v[128:131] offset:0
    v_mfma_f32_16x16x32_f16 v[156:159], v[68:71], v[108:111], v[156:159]
    ds_write_b128 v9, v[132:135] offset:1024
    s_waitcnt lgkmcnt(12)
    v_mfma_f32_16x16x32_f16 v[136:139], v[72:75], v[96:99], v[136:139]
    s_waitcnt lgkmcnt(10)
    v_mfma_f32_16x16x32_f16 v[140:143], v[76:79], v[96:99], v[140:143]
    v_mfma_f32_16x16x32_f16 v[144:147], v[72:75], v[100:103], v[144:147]
    v_mfma_f32_16x16x32_f16 v[148:151], v[76:79], v[100:103], v[148:151]
    v_mfma_f32_16x16x32_f16 v[152:155], v[72:75], v[104:107], v[152:155]
    v_mfma_f32_16x16x32_f16 v[156:159], v[76:79], v[104:107], v[156:159]
    s_waitcnt lgkmcnt(8)
    v_mfma_f32_16x16x32_f16 v[144:147], v[80:83], v[96:99], v[144:147]
    ds_write_b128 v9, v[136:139] offset:8192
    s_waitcnt lgkmcnt(7)
    v_mfma_f32_16x16x32_f16 v[148:151], v[84:87], v[96:99], v[148:151]
    ds_write_b128 v9, v[140:143] offset:9216
    v_mfma_f32_16x16x32_f16 v[152:155], v[80:83], v[100:103], v[152:155]
    v_mfma_f32_16x16x32_f16 v[156:159], v[84:87], v[100:103], v[156:159]
    s_waitcnt lgkmcnt(6)
    v_mfma_f32_16x16x32_f16 v[152:155], v[88:91], v[96:99], v[152:155]
    s_waitcnt lgkmcnt(4)
    v_mfma_f32_16x16x32_f16 v[156:159], v[92:95], v[96:99], v[156:159]
    ds_write_b128 v9, v[144:147] offset:16384
    ds_write_b128 v9, v[148:151] offset:17408
    s_nop 3
    ds_write_b128 v9, v[152:155] offset:24576
    s_nop 0
    ds_write_b128 v9, v[156:159] offset:25600
    v_mov_b32 v14, s36
    v_mov_b32 v15, 1
    s_mov_b64 exec, 1
    ds_add_u32 v14, v15
    s_mov_b64 exec, -1
    s_setprio 0
    s_cmp_eq_u32 s38, 0
    s_cbranch_scc1 k12_xl2
    buffer_load_dwordx4 v[164:167], v13, s[24:27], s23 offen sc1
k12_xl2:
    v_lshrrev_b32 v7, 4, v6
    v_mul_u32_u24 v7, 163840, v7
    v_and_b32 v6, 15, v6
    v_lshl_add_u32 v6, v6, 4, v7
    s_mul_i32 s22, s57, 655360
    s_lshl_b32 s23, s21, 8
    s_add_u32 s22, s22, s23
    v_mov_b32 v14, s36
    s_waitcnt lgkmcnt(0)
    s_mov_b32 s68, 0x40000
k12_s9:
    s_sub_u32 s68, s68, 1
    s_cbranch_scc1 k12_s9_x
    ds_read_b32 v15, v14
    s_waitcnt lgkmcnt(0)
    v_readfirstlane_b32 s49, v15
    s_nop 0
    s_cmp_lt_u32 s49, 4
    s_cbranch_scc1 k12_s9
k12_s9_x:
    ds_read_b128 v[32:35], v8 offset:0
    ds_read_b128 v[36:39], v8 offset:1024
    ds_read_b128 v[40:43], v8 offset:2048
    ds_read_b128 v[44:47], v8 offset:3072
    ds_read_b128 v[48:51], v8 offset:4096
    ds_read_b128 v[52:55], v8 offset:5120
    ds_read_b128 v[56:59], v8 offset:6144
    ds_read_b128 v[60:63], v8 offset:7168
    s_waitcnt lgkmcnt(5)
    v_pk_add_f32 v[16:17], v[32:33], v[40:41]
    v_pk_add_f32 v[18:19], v[34:35], v[42:43]
    s_waitcnt lgkmcnt(4)
    v_pk_add_f32 v[20:21], v[36:37], v[44:45]
    v_pk_add_f32 v[22:23], v[38:39], v[46:47]
    s_waitcnt lgkmcnt(1)
    v_pk_add_f32 v[48:49], v[48:49], v[56:57]
    v_pk_add_f32 v[50:51], v[50:51], v[58:59]
    s_waitcnt lgkmcnt(0)
    v_pk_add_f32 v[52:53], v[52:53], v[60:61]
    v_pk_add_f32 v[54:55], v[54:55], v[62:63]
    v_pk_add_f32 v[16:17], v[16:17], v[48:49]
    v_pk_add_f32 v[18:19], v[18:19], v[50:51]
    v_pk_add_f32 v[20:21], v[20:21], v[52:53]
    v_pk_add_f32 v[22:23], v[22:23], v[54:55]
    v_pk_mul_f32 v[16:17], v[16:17], v[2:3] op_sel_hi:[1,0]
    v_pk_mul_f32 v[18:19], v[18:19], v[2:3] op_sel_hi:[1,0]
    v_pk_mul_f32 v[20:21], v[20:21], v[2:3] op_sel_hi:[1,0]
    v_pk_mul_f32 v[22:23], v[22:23], v[2:3] op_sel_hi:[1,0]
    s_waitcnt vmcnt(0)
    v_lshlrev_b32 v120, 16, v164
    v_and_b32 v121, s48, v164
    v_lshlrev_b32 v122, 16, v165
    v_and_b32 v123, s48, v165
    v_lshlrev_b32 v124, 16, v166
    v_and_b32 v125, s48, v166
    v_lshlrev_b32 v126, 16, v167
    v_and_b32 v127, s48, v167
    v_cvt_pk_bf16_f32 v24, v16, v17
    v_cvt_pk_bf16_f32 v25, v18, v19
    v_cvt_pk_bf16_f32 v26, v20, v21
    v_cvt_pk_bf16_f32 v27, v22, v23
    s_nop 0
    v_permlane16_swap_b32 v24, v26
    v_permlane16_swap_b32 v25, v27
    v_dot2_f32_bf16 v32, v24, s51, v112
    v_dot2_f32_bf16 v33, v24, s52, v113
    v_dot2_f32_bf16 v34, v25, s51, v114
    v_dot2_f32_bf16 v35, v25, s52, v115
    v_dot2_f32_bf16 v36, v26, s51, v116
    v_dot2_f32_bf16 v37, v26, s52, v117
    v_dot2_f32_bf16 v38, v27, s51, v118
    v_dot2_f32_bf16 v39, v27, s52, v119
    v_cvt_pk_bf16_f32 v24, v32, v33
    v_cvt_pk_bf16_f32 v25, v34, v35
    v_cvt_pk_bf16_f32 v26, v36, v37
    v_cvt_pk_bf16_f32 v27, v38, v39
    v_dot2_f32_bf16 v32, v24, s51, v120
    v_dot2_f32_bf16 v33, v24, s52, v121
    v_dot2_f32_bf16 v34, v25, s51, v122
    v_dot2_f32_bf16 v35, v25, s52, v123
    v_dot2_f32_bf16 v36, v26, s51, v124
    v_dot2_f32_bf16 v37, v26, s52, v125
    v_dot2_f32_bf16 v38, v27, s51, v126
    v_dot2_f32_bf16 v39, v27, s52, v127
    v_cvt_pk_bf16_f32 v24, v32, v33
    v_cvt_pk_bf16_f32 v25, v34, v35
    v_cvt_pk_bf16_f32 v26, v36, v37
    v_cvt_pk_bf16_f32 v27, v38, v39
    buffer_store_dwordx4 v[24:27], v6, s[40:43], s22 offen sc1
    s_cmp_eq_u32 s69, 0
    s_cbranch_scc1 k12_fin
    s_mov_b32 s41, s70
    s_mov_b32 s42, s71
    s_mov_b32 s55, s72
    s_add_u32 s28, s16, 20971520
    s_addc_u32 s29, s17, 0
    s_mov_b32 s30, 3932160
    s_mov_b32 s31, 0x20000
    s_add_u32 s64, s16, 18874368
    s_addc_u32 s65, s17, 0
    s_mov_b32 s66, 122880
    s_mov_b32 s67, 0x20000
    v_lshrrev_b32 v1, 4, v0
    v_bfe_u32 v2, v0, 2, 2
    v_bfe_u32 v3, v0, 4, 1
    v_lshl_add_u32 v2, v3, 2, v2
    v_and_b32 v3, 3, v0
    v_lshrrev_b32 v5, 1, v1
    v_lshlrev_b32 v5, 11, v5
    v_lshl_add_u32 v5, v2, 5, v5
    v_lshl_add_u32 v5, v3, 3, v5
    v_add_u32 v5, s55, v5
    v_lshlrev_b32 v6, 4, v0
    ds_read_b64_tr_b16 v[48:49], v5 offset:0
    ds_read_b64_tr_b16 v[50:51], v5 offset:1024
    ds_read_b64_tr_b16 v[52:53], v5 offset:256
    ds_read_b64_tr_b16 v[54:55], v5 offset:1280
    ds_read_b64_tr_b16 v[56:57], v5 offset:512
    ds_read_b64_tr_b16 v[58:59], v5 offset:1536
    ds_read_b64_tr_b16 v[60:61], v5 offset:768
    ds_read_b64_tr_b16 v[62:63], v5 offset:1792
    ds_read_b64_tr_b16 v[64:65], v5 offset:4096
    ds_read_b64_tr_b16 v[66:67], v5 offset:5120
    ds_read_b64_tr_b16 v[68:69], v5 offset:4352
    ds_read_b64_tr_b16 v[70:71], v5 offset:5376
    ds_read_b64_tr_b16 v[72:73], v5 offset:4608
    ds_read_b64_tr_b16 v[74:75], v5 offset:5632
    ds_read_b64_tr_b16 v[76:77], v5 offset:4864
    ds_read_b64_tr_b16 v[78:79], v5 offset:5888
    s_add_u32 s40, s42, 0
    s_waitcnt lgkmcnt(14)
    buffer_store_dwordx4 v[48:51], v6, s[28:31], s40 offen sc1
    s_add_u32 s40, s42, 2048
    s_waitcnt lgkmcnt(12)
    buffer_store_dwordx4 v[52:55], v6, s[28:31], s40 offen sc1
    s_add_u32 s40, s42, 4096
    s_waitcnt lgkmcnt(10)
    buffer_store_dwordx4 v[56:59], v6, s[28:31], s40 offen sc1
    s_add_u32 s40, s42, 6144
    s_waitcnt lgkmcnt(8)
    buffer_store_dwordx4 v[60:63], v6, s[28:31], s40 offen sc1
    s_add_u32 s40, s42, 196608
    s_waitcnt lgkmcnt(6)
    buffer_store_dwordx4 v[64:67], v6, s[28:31], s40 offen sc1
    s_add_u32 s40, s42, 198656
    s_waitcnt lgkmcnt(4)
    buffer_store_dwordx4 v[68:71], v6, s[28:31], s40 offen sc1
    s_add_u32 s40, s42, 200704
    s_waitcnt lgkmcnt(2)
    buffer_store_dwordx4 v[72:75], v6, s[28:31], s40 offen sc1
    s_add_u32 s40, s42, 202752
    s_waitcnt lgkmcnt(0)
    buffer_store_dwordx4 v[76:79], v6, s[28:31], s40 offen sc1
    s_mov_b32 s46, 0x3f803f80
    v_dot2_f32_bf16 v8, v48, s46, 0
    v_dot2_f32_bf16 v9, v52, s46, 0
    v_dot2_f32_bf16 v10, v56, s46, 0
    v_dot2_f32_bf16 v11, v60, s46, 0
    v_dot2_f32_bf16 v8, v49, s46, v8
    v_dot2_f32_bf16 v9, v53, s46, v9
    v_dot2_f32_bf16 v10, v57, s46, v10
    v_dot2_f32_bf16 v11, v61, s46, v11
    v_dot2_f32_bf16 v8, v50, s46, v8
    v_dot2_f32_bf16 v9, v54, s46, v9
    v_dot2_f32_bf16 v10, v58, s46, v10
    v_dot2_f32_bf16 v11, v62, s46, v11
    v_dot2_f32_bf16 v8, v51, s46, v8
    v_dot2_f32_bf16 v9, v55, s46, v9
    v_dot2_f32_bf16 v10, v59, s46, v10
    v_dot2_f32_bf16 v11, v63, s46, v11
    v_dot2_f32_bf16 v8, v64, s46, v8
    v_dot2_f32_bf16 v9, v68, s46, v9
    v_dot2_f32_bf16 v10, v72, s46, v10
    v_dot2_f32_bf16 v11, v76, s46, v11
    v_dot2_f32_bf16 v8, v65, s46, v8
    v_dot2_f32_bf16 v9, v69, s46, v9
    v_dot2_f32_bf16 v10, v73, s46, v10
    v_dot2_f32_bf16 v11, v77, s46, v11
    v_dot2_f32_bf16 v8, v66, s46, v8
    v_dot2_f32_bf16 v9, v70, s46, v9
    v_dot2_f32_bf16 v10, v74, s46, v10
    v_dot2_f32_bf16 v11, v78, s46, v11
    v_dot2_f32_bf16 v8, v67, s46, v8
    v_dot2_f32_bf16 v9, v71, s46, v9
    v_dot2_f32_bf16 v10, v75, s46, v10
    v_dot2_f32_bf16 v11, v79, s46, v11
    v_mov_b32 v12, v8
    v_mov_b32 v13, v9
    v_mov_b32 v14, v10
    v_mov_b32 v15, v11
    v_permlane16_swap_b32 v8, v12
    v_permlane16_swap_b32 v9, v13
    v_permlane16_swap_b32 v10, v14
    v_permlane16_swap_b32 v11, v15
    v_add_f32 v8, v8, v12
    v_add_f32 v9, v9, v13
    v_add_f32 v10, v10, v14
    v_add_f32 v11, v11, v15
    v_mov_b32 v12, v8
    v_mov_b32 v13, v9
    v_mov_b32 v14, v10
    v_mov_b32 v15, v11
    v_permlane32_swap_b32 v8, v12
    v_permlane32_swap_b32 v9, v13
    v_permlane32_swap_b32 v10, v14
    v_permlane32_swap_b32 v11, v15
    v_add_f32 v8, v8, v12
    v_add_f32 v9, v9, v13
    v_add_f32 v10, v10, v14
    v_add_f32 v11, v11, v15
    v_cmp_eq_u32 vcc, 1, v1
    s_nop 1
    v_cndmask_b32 v8, v8, v9, vcc
    v_cmp_eq_u32 vcc, 2, v1
    s_nop 1
    v_cndmask_b32 v8, v8, v10, vcc
    v_cmp_eq_u32 vcc, 3, v1
    s_nop 1
    v_cndmask_b32 v8, v8, v11, vcc
    v_lshlrev_b32 v6, 2, v0
    buffer_store_dword v8, v6, s[64:67], s41 offen
k12_fin:
k12_end:
    s_endpgm

.globl ffn_kernel
.p2align 8
.type ffn_kernel,@function
ffn_kernel:
    s_cmp_ge_u32 s2, 256
    s_cbranch_scc1 k3_end
    s_load_dwordx2 s[16:17], s[0:1], 104
    s_load_dwordx2 s[10:11], s[0:1], 88
    v_lshrrev_b32 v1, 6, v0
    v_and_b32 v0, 63, v0
    v_readfirstlane_b32 s20, v1
    s_lshr_b32 s21, s2, 3
    s_and_b32 s22, s21, 3
    s_bfe_u32 s23, s2, 0x20001
    s_lshl_b32 s23, s23, 2
    s_add_u32 s22, s22, s23
    s_lshr_b32 s21, s21, 2
    s_and_b32 s23, s2, 1
    s_lshl_b32 s23, s23, 3
    s_add_u32 s21, s21, s23
    s_cmp_ge_u32 s20, 4
    s_cbranch_scc1 k3_help
    s_lshl_b32 s41, s20, 1
    v_lshrrev_b32 v1, 4, v0
    v_bfe_u32 v2, v0, 2, 2
    v_bfe_u32 v3, v0, 4, 1
    v_lshl_add_u32 v2, v3, 2, v2
    v_and_b32 v3, 3, v0
    v_lshrrev_b32 v4, 1, v1
    v_lshlrev_b32 v4, 12, v4
    v_lshl_add_u32 v4, v2, 8, v4
    v_lshl_add_u32 v4, v3, 3, v4
    s_add_u32 s43, s41, 0
    v_xor_b32 v8, s43, v2
    v_lshl_add_u32 v8, v8, 5, v4
    s_add_u32 s43, s41, 1
    v_xor_b32 v9, s43, v2
    v_lshl_add_u32 v9, v9, 5, v4
    v_lshlrev_b32 v7, 4, v0
    v_add_u32 v10, 8192, v7
    s_mov_b32 s60, 0
    s_waitcnt lgkmcnt(0)
    s_add_u32 s28, s16, 11534336
    s_addc_u32 s29, s17, 0
    s_mov_b32 s30, 6291456
    s_mov_b32 s31, 0x20000
    s_add_u32 s36, s16, 25165824
    s_addc_u32 s37, s17, 0
    s_mov_b32 s38, 1966080
    s_mov_b32 s39, 0x20000
    s_lshr_b32 s43, s21, 3
    s_lshl_b32 s43, s43, 2
    s_and_b32 s47, s21, 3
    s_add_u32 s47, s47, s43
    s_mul_i32 s65, s20, 480
    s_mul_i32 s44, s47, 5
    s_add_u32 s65, s65, s44
    s_add_u32 s65, s65, 200
    s_lshl_b32 s65, s65, 10
    s_mul_i32 s66, s20, 5120
    s_add_u32 s66, s66, 81920
    s_mov_b32 s67, 0
    s_mov_b32 s62, 16
    s_mov_b32 s70, 36864
    s_mov_b32 s71, 16384
    s_cmp_lg_u32 s20, 0
    s_cbranch_scc1 k3_nocs0
    s_add_u32 s32, s16, 18874368
    s_addc_u32 s33, s17, 0
    s_mov_b32 s34, 122880
    s_mov_b32 s35, 0x20000
    v_cmp_gt_u32 vcc, 24, v0
    s_nop 1
    v_cndmask_b32_e64 v5, 24, 0, vcc
    v_sub_u32 v6, v0, v5
    v_lshlrev_b32 v6, 4, v6
    v_lshl_add_u32 v6, v5, 8, v6
    s_mul_i32 s44, s21, 384
    buffer_load_dwordx4 v[224:227], v6, s[32:35], s44 offen
    s_add_u32 s44, s44, 12288
    buffer_load_dwordx4 v[228:231], v6, s[32:35], s44 offen
    s_add_u32 s44, s44, 12288
    buffer_load_dwordx4 v[232:235], v6, s[32:35], s44 offen
    s_add_u32 s44, s44, 12288
    buffer_load_dwordx4 v[236:239], v6, s[32:35], s44 offen
    s_add_u32 s44, s44, 12288
    buffer_load_dwordx4 v[240:243], v6, s[32:35], s44 offen
    s_add_u32 s44, s44, 12288
    buffer_load_dwordx4 v[244:247], v6, s[32:35], s44 offen
    s_add_u32 s44, s44, 12288
    buffer_load_dwordx4 v[248:251], v6, s[32:35], s44 offen
    s_add_u32 s44, s44, 12288
    buffer_load_dwordx4 v[252:255], v6, s[32:35], s44 offen
    s_add_u32 s44, s44, 12288
    buffer_load_dwordx4 v[72:75], v6, s[32:35], s44 offen
    s_add_u32 s44, s44, 12288
    buffer_load_dwordx4 v[76:79], v6, s[32:35], s44 offen
    s_add_u32 s44, s44, 12288
    v_add_u32 v6, 161024, v7
k3_nocs0:
    v_mov_b32 v11, v8
    v_mov_b32 v12, v9
    v_mov_b32 v13, v10
    s_barrier
    ds_read_b64_tr_b16 v[64:65], v11
    ds_read_b64_tr_b16 v[66:67], v11 offset:2048
    ds_read_b128 v[16:19], v13 offset:0
    ds_read_b64_tr_b16 v[68:69], v12
    ds_read_b64_tr_b16 v[70:71], v12 offset:2048
    ds_read_b128 v[20:23], v13 offset:1024
    ds_read_b128 v[24:27], v13 offset:2048
    ds_read_b128 v[28:31], v13 offset:3072
    ds_read_b128 v[32:35], v13 offset:4096
    ds_read_b128 v[36:39], v13 offset:5120
    ds_read_b128 v[40:43], v13 offset:6144
    ds_read_b128 v[44:47], v13 offset:7168
    ds_read_b128 v[48:51], v13 offset:8192
    ds_read_b128 v[52:55], v13 offset:9216
    ds_read_b128 v[56:59], v13 offset:10240
    ds_read_b128 v[60:63], v13 offset:11264
    s_add_u32 s60, s60, 20480
    s_cmp_eq_u32 s60, 81920
    s_cselect_b32 s60, 0, s60
    v_add_u32 v11, s60, v8
    v_add_u32 v12, s60, v9
    v_add_u32 v13, s60, v10
    s_cmp_lg_u32 s20, 0
    s_cbranch_scc1 k3_nocs
    s_waitcnt vmcnt(0)
    v_pk_add_f32 v[224:225], v[224:225], v[228:229]
    v_pk_add_f32 v[226:227], v[226:227], v[230:231]
    v_pk_add_f32 v[232:233], v[232:233], v[236:237]
    v_pk_add_f32 v[234:235], v[234:235], v[238:239]
    v_pk_add_f32 v[240:241], v[240:241], v[244:245]
    v_pk_add_f32 v[242:243], v[242:243], v[246:247]
    v_pk_add_f32 v[248:249], v[248:249], v[252:253]
    v_pk_add_f32 v[250:251], v[250:251], v[254:255]
    v_pk_add_f32 v[72:73], v[72:73], v[76:77]
    v_pk_add_f32 v[74:75], v[74:75], v[78:79]
    v_pk_add_f32 v[224:225], v[224:225], v[232:233]
    v_pk_add_f32 v[226:227], v[226:227], v[234:235]
    v_pk_add_f32 v[240:241], v[240:241], v[248:249]
    v_pk_add_f32 v[242:243], v[242:243], v[250:251]
    v_pk_add_f32 v[224:225], v[224:225], v[240:241]
    v_pk_add_f32 v[226:227], v[226:227], v[242:243]
    v_pk_add_f32 v[224:225], v[224:225], v[72:73]
    v_pk_add_f32 v[226:227], v[226:227], v[74:75]
    ds_write_b128 v6, v[224:227]
k3_nocs:
    s_waitcnt lgkmcnt(0)
    s_barrier
    v_mfma_f32_16x16x32_bf16 v[128:131], v[16:19], v[64:67], 0
    ds_read_b64_tr_b16 v[120:121], v11
    v_mfma_f32_16x16x32_bf16 v[132:135], v[16:19], v[68:71], 0
    ds_read_b64_tr_b16 v[122:123], v11 offset:2048
    v_mfma_f32_16x16x32_bf16 v[136:139], v[20:23], v[64:67], 0
    ds_read_b128 v[72:75], v13 offset:0
    v_mfma_f32_16x16x32_bf16 v[140:143], v[20:23], v[68:71], 0
    ds_read_b64_tr_b16 v[124:125], v12
    v_mfma_f32_16x16x32_bf16 v[144:147], v[24:27], v[64:67], 0
    ds_read_b64_tr_b16 v[126:127], v12 offset:2048
    v_mfma_f32_16x16x32_bf16 v[148:151], v[24:27], v[68:71], 0
    ds_read_b128 v[76:79], v13 offset:1024
    v_mfma_f32_16x16x32_bf16 v[152:155], v[28:31], v[64:67], 0
    ds_read_b128 v[80:83], v13 offset:2048
    v_mfma_f32_16x16x32_bf16 v[156:159], v[28:31], v[68:71], 0
    ds_read_b128 v[84:87], v13 offset:3072
    v_mfma_f32_16x16x32_bf16 v[160:163], v[32:35], v[64:67], 0
    ds_read_b128 v[88:91], v13 offset:4096
    v_mfma_f32_16x16x32_bf16 v[164:167], v[32:35], v[68:71], 0
    ds_read_b128 v[92:95], v13 offset:5120
    v_mfma_f32_16x16x32_bf16 v[168:171], v[36:39], v[64:67], 0
    ds_read_b128 v[96:99], v13 offset:6144
    v_mfma_f32_16x16x32_bf16 v[172:175], v[36:39], v[68:71], 0
    ds_read_b128 v[100:103], v13 offset:7168
    v_mfma_f32_16x16x32_bf16 v[176:179], v[40:43], v[64:67], 0
    ds_read_b128 v[104:107], v13 offset:8192
    v_mfma_f32_16x16x32_bf16 v[180:183], v[40:43], v[68:71], 0
    ds_read_b128 v[108:111], v13 offset:9216
    v_mfma_f32_16x16x32_bf16 v[184:187], v[44:47], v[64:67], 0
    ds_read_b128 v[112:115], v13 offset:10240
    v_mfma_f32_16x16x32_bf16 v[188:191], v[44:47], v[68:71], 0
    ds_read_b128 v[116:119], v13 offset:11264
    v_mfma_f32_16x16x32_bf16 v[192:195], v[48:51], v[64:67], 0
    s_add_u32 s60, s60, 20480
    v_mfma_f32_16x16x32_bf16 v[196:199], v[48:51], v[68:71], 0
    s_cmp_eq_u32 s60, 81920
    v_mfma_f32_16x16x32_bf16 v[200:203], v[52:55], v[64:67], 0
    s_cselect_b32 s60, 0, s60
    v_mfma_f32_16x16x32_bf16 v[204:207], v[52:55], v[68:71], 0
    v_add_u32 v11, s60, v8
    v_mfma_f32_16x16x32_bf16 v[208:211], v[56:59], v[64:67], 0
    v_add_u32 v12, s60, v9
    v_mfma_f32_16x16x32_bf16 v[212:215], v[56:59], v[68:71], 0
    v_add_u32 v13, s60, v10
    v_mfma_f32_16x16x32_bf16 v[216:219], v[60:63], v[64:67], 0
    v_mfma_f32_16x16x32_bf16 v[220:223], v[60:63], v[68:71], 0
    s_waitcnt lgkmcnt(0)
    s_mov_b32 s57, 0
k3_loop:
    s_barrier
    v_mfma_f32_16x16x32_bf16 v[128:131], v[72:75], v[120:123], v[128:131]
    ds_read_b64_tr_b16 v[64:65], v11
    v_mfma_f32_16x16x32_bf16 v[132:135], v[72:75], v[124:127], v[132:135]
    ds_read_b64_tr_b16 v[66:67], v11 offset:2048
    v_mfma_f32_16x16x32_bf16 v[136:139], v[76:79], v[120:123], v[136:139]
    ds_read_b128 v[16:19], v13 offset:0
    s_mov_b32 m0, s66
    v_mfma_f32_16x16x32_bf16 v[140:143], v[76:79], v[124:127], v[140:143]
    ds_read_b64_tr_b16 v[68:69], v12
    s_add_u32 s67, s67, 1
    v_mfma_f32_16x16x32_bf16 v[144:147], v[80:83], v[120:123], v[144:147]
    ds_read_b64_tr_b16 v[70:71], v12 offset:2048
    s_cmp_eq_u32 s67, 5
    v_mfma_f32_16x16x32_bf16 v[148:151], v[80:83], v[124:127], v[148:151]
    ds_read_b128 v[20:23], v13 offset:1024
    s_cselect_b32 s67, 0, s67
    v_mfma_f32_16x16x32_bf16 v[152:155], v[84:87], v[120:123], v[152:155]
    ds_read_b128 v[24:27], v13 offset:2048
    s_cselect_b32 s63, s70, 1024
    v_mfma_f32_16x16x32_bf16 v[156:159], v[84:87], v[124:127], v[156:159]
    ds_read_b128 v[28:31], v13 offset:3072
    s_cselect_b32 s69, s71, 1024
    v_mfma_f32_16x16x32_bf16 v[160:163], v[88:91], v[120:123], v[160:163]
    ds_read_b128 v[32:35], v13 offset:4096
    s_sub_u32 s62, s62, 1
    v_mfma_f32_16x16x32_bf16 v[164:167], v[88:91], v[124:127], v[164:167]
    ds_read_b128 v[36:39], v13 offset:5120
    s_cselect_b32 s63, 0, s63
    v_mfma_f32_16x16x32_bf16 v[168:171], v[92:95], v[120:123], v[168:171]
    ds_read_b128 v[40:43], v13 offset:6144
    s_cselect_b32 s69, 0, s69
    v_mfma_f32_16x16x32_bf16 v[172:175], v[92:95], v[124:127], v[172:175]
    ds_read_b128 v[44:47], v13 offset:7168
    s_cselect_b32 s62, 0, s62
    v_mfma_f32_16x16x32_bf16 v[176:179], v[96:99], v[120:123], v[176:179]
    ds_read_b128 v[48:51], v13 offset:8192
    s_add_u32 s66, s66, s69
    v_mfma_f32_16x16x32_bf16 v[180:183], v[96:99], v[124:127], v[180:183]
    ds_read_b128 v[52:55], v13 offset:9216
    v_mfma_f32_16x16x32_bf16 v[184:187], v[100:103], v[120:123], v[184:187]
    ds_read_b128 v[56:59], v13 offset:10240
    v_mfma_f32_16x16x32_bf16 v[188:191], v[100:103], v[124:127], v[188:191]
    ds_read_b128 v[60:63], v13 offset:11264
    v_mfma_f32_16x16x32_bf16 v[192:195], v[104:107], v[120:123], v[192:195]
    s_add_u32 s60, s60, 20480
    v_mfma_f32_16x16x32_bf16 v[196:199], v[104:107], v[124:127], v[196:199]
    s_cmp_eq_u32 s60, 81920
    v_mfma_f32_16x16x32_bf16 v[200:203], v[108:111], v[120:123], v[200:203]
    s_cselect_b32 s60, 0, s60
    v_mfma_f32_16x16x32_bf16 v[204:207], v[108:111], v[124:127], v[204:207]
    v_add_u32 v11, s60, v8
    v_mfma_f32_16x16x32_bf16 v[208:211], v[112:115], v[120:123], v[208:211]
    v_add_u32 v12, s60, v9
    v_mfma_f32_16x16x32_bf16 v[212:215], v[112:115], v[124:127], v[212:215]
    v_add_u32 v13, s60, v10
    buffer_load_dwordx4 v7, s[36:39], s65 offen lds
    v_mfma_f32_16x16x32_bf16 v[216:219], v[116:119], v[120:123], v[216:219]
    v_mfma_f32_16x16x32_bf16 v[220:223], v[116:119], v[124:127], v[220:223]
    s_add_u32 s65, s65, s63
    s_waitcnt lgkmcnt(0)
    s_barrier
    v_mfma_f32_16x16x32_bf16 v[128:131], v[16:19], v[64:67], v[128:131]
    ds_read_b64_tr_b16 v[120:121], v11
    v_mfma_f32_16x16x32_bf16 v[132:135], v[16:19], v[68:71], v[132:135]
    ds_read_b64_tr_b16 v[122:123], v11 offset:2048
    v_mfma_f32_16x16x32_bf16 v[136:139], v[20:23], v[64:67], v[136:139]
    ds_read_b128 v[72:75], v13 offset:0
    s_mov_b32 m0, s66
    v_mfma_f32_16x16x32_bf16 v[140:143], v[20:23], v[68:71], v[140:143]
    ds_read_b64_tr_b16 v[124:125], v12
    s_add_u32 s67, s67, 1
    v_mfma_f32_16x16x32_bf16 v[144:147], v[24:27], v[64:67], v[144:147]
    ds_read_b64_tr_b16 v[126:127], v12 offset:2048
    s_cmp_eq_u32 s67, 5
    v_mfma_f32_16x16x32_bf16 v[148:151], v[24:27], v[68:71], v[148:151]
    ds_read_b128 v[76:79], v13 offset:1024
    s_cselect_b32 s67, 0, s67
    v_mfma_f32_16x16x32_bf16 v[152:155], v[28:31], v[64:67], v[152:155]
    ds_read_b128 v[80:83], v13 offset:2048
    s_cselect_b32 s63, s70, 1024
    v_mfma_f32_16x16x32_bf16 v[156:159], v[28:31], v[68:71], v[156:159]
    ds_read_b128 v[84:87], v13 offset:3072
    s_cselect_b32 s69, s71, 1024
    v_mfma_f32_16x16x32_bf16 v[160:163], v[32:35], v[64:67], v[160:163]
    ds_read_b128 v[88:91], v13 offset:4096
    s_sub_u32 s62, s62, 1
    v_mfma_f32_16x16x32_bf16 v[164:167], v[32:35], v[68:71], v[164:167]
    ds_read_b128 v[92:95], v13 offset:5120
    s_cselect_b32 s63, 0, s63
    v_mfma_f32_16x16x32_bf16 v[168:171], v[36:39], v[64:67], v[168:171]
    ds_read_b128 v[96:99], v13 offset:6144
    s_cselect_b32 s69, 0, s69
    v_mfma_f32_16x16x32_bf16 v[172:175], v[36:39], v[68:71], v[172:175]
    ds_read_b128 v[100:103], v13 offset:7168
    s_cselect_b32 s62, 0, s62
    v_mfma_f32_16x16x32_bf16 v[176:179], v[40:43], v[64:67], v[176:179]
    ds_read_b128 v[104:107], v13 offset:8192
    s_add_u32 s66, s66, s69
    v_mfma_f32_16x16x32_bf16 v[180:183], v[40:43], v[68:71], v[180:183]
    ds_read_b128 v[108:111], v13 offset:9216
    v_mfma_f32_16x16x32_bf16 v[184:187], v[44:47], v[64:67], v[184:187]
    ds_read_b128 v[112:115], v13 offset:10240
    v_mfma_f32_16x16x32_bf16 v[188:191], v[44:47], v[68:71], v[188:191]
    ds_read_b128 v[116:119], v13 offset:11264
    v_mfma_f32_16x16x32_bf16 v[192:195], v[48:51], v[64:67], v[192:195]
    s_add_u32 s60, s60, 20480
    v_mfma_f32_16x16x32_bf16 v[196:199], v[48:51], v[68:71], v[196:199]
    s_cmp_eq_u32 s60, 81920
    v_mfma_f32_16x16x32_bf16 v[200:203], v[52:55], v[64:67], v[200:203]
    s_cselect_b32 s60, 0, s60
    v_mfma_f32_16x16x32_bf16 v[204:207], v[52:55], v[68:71], v[204:207]
    v_add_u32 v11, s60, v8
    v_mfma_f32_16x16x32_bf16 v[208:211], v[56:59], v[64:67], v[208:211]
    v_add_u32 v12, s60, v9
    v_mfma_f32_16x16x32_bf16 v[212:215], v[56:59], v[68:71], v[212:215]
    v_add_u32 v13, s60, v10
    buffer_load_dwordx4 v7, s[36:39], s65 offen lds
    v_mfma_f32_16x16x32_bf16 v[216:219], v[60:63], v[64:67], v[216:219]
    v_mfma_f32_16x16x32_bf16 v[220:223], v[60:63], v[68:71], v[220:223]
    s_add_u32 s65, s65, s63
    s_waitcnt lgkmcnt(0)
    s_add_u32 s57, s57, 1
    s_cmp_lt_u32 s57, 9
    s_cbranch_scc1 k3_loop
    v_lshlrev_b32 v5, 4, v1
    v_add_u32 v5, 161024, v5
    ds_read_b128 v[16:19], v5 offset:0
    ds_read_b128 v[20:23], v5 offset:384
    ds_read_b128 v[24:27], v5 offset:64
    ds_read_b128 v[28:31], v5 offset:448
    ds_read_b128 v[32:35], v5 offset:128
    ds_read_b128 v[36:39], v5 offset:512
    ds_read_b128 v[40:43], v5 offset:192
    ds_read_b128 v[44:47], v5 offset:576
    ds_read_b128 v[48:51], v5 offset:256
    ds_read_b128 v[52:55], v5 offset:640
    ds_read_b128 v[56:59], v5 offset:320
    ds_read_b128 v[60:63], v5 offset:704
    s_lshl_b32 s43, s22, 3
    s_add_u32 s43, s43, s41
    s_mul_i32 s43, s43, 48
    s_mul_i32 s44, s21, 3
    s_add_u32 s43, s43, s44
    s_lshl_b32 s52, s43, 10
    s_add_u32 s53, s52, 49152
    v_and_b32 v2, 15, v0
    s_lshl_b32 s43, s41, 8
    s_add_u32 s43, s43, 161792
    v_lshl_add_u32 v3, v2, 4, s43
    v_mfma_f32_16x16x32_bf16 v[128:131], v[72:75], v[120:123], v[128:131]
    v_mfma_f32_16x16x32_bf16 v[132:135], v[72:75], v[124:127], v[132:135]
    v_mfma_f32_16x16x32_bf16 v[136:139], v[76:79], v[120:123], v[136:139]
    v_mfma_f32_16x16x32_bf16 v[140:143], v[76:79], v[124:127], v[140:143]
    v_mfma_f32_16x16x32_bf16 v[144:147], v[80:83], v[120:123], v[144:147]
    v_mfma_f32_16x16x32_bf16 v[148:151], v[80:83], v[124:127], v[148:151]
    v_mfma_f32_16x16x32_bf16 v[152:155], v[84:87], v[120:123], v[152:155]
    v_mfma_f32_16x16x32_bf16 v[156:159], v[84:87], v[124:127], v[156:159]
    v_mfma_f32_16x16x32_bf16 v[160:163], v[88:91], v[120:123], v[160:163]
    v_mfma_f32_16x16x32_bf16 v[164:167], v[88:91], v[124:127], v[164:167]
    v_mfma_f32_16x16x32_bf16 v[168:171], v[92:95], v[120:123], v[168:171]
    v_mfma_f32_16x16x32_bf16 v[172:175], v[92:95], v[124:127], v[172:175]
    v_mfma_f32_16x16x32_bf16 v[176:179], v[96:99], v[120:123], v[176:179]
    v_mfma_f32_16x16x32_bf16 v[180:183], v[96:99], v[124:127], v[180:183]
    v_mfma_f32_16x16x32_bf16 v[184:187], v[100:103], v[120:123], v[184:187]
    v_mfma_f32_16x16x32_bf16 v[188:191], v[100:103], v[124:127], v[188:191]
    v_mfma_f32_16x16x32_bf16 v[192:195], v[104:107], v[120:123], v[192:195]
    v_mfma_f32_16x16x32_bf16 v[196:199], v[104:107], v[124:127], v[196:199]
    v_mfma_f32_16x16x32_bf16 v[200:203], v[108:111], v[120:123], v[200:203]
    v_mfma_f32_16x16x32_bf16 v[204:207], v[108:111], v[124:127], v[204:207]
    v_mfma_f32_16x16x32_bf16 v[208:211], v[112:115], v[120:123], v[208:211]
    v_mfma_f32_16x16x32_bf16 v[212:215], v[112:115], v[124:127], v[212:215]
    v_mfma_f32_16x16x32_bf16 v[216:219], v[116:119], v[120:123], v[216:219]
    v_mfma_f32_16x16x32_bf16 v[220:223], v[116:119], v[124:127], v[220:223]
    s_waitcnt lgkmcnt(0)
    s_barrier
    ds_read_b128 v[64:67], v3 offset:0
    ds_read_b128 v[68:71], v3 offset:256
    s_waitcnt lgkmcnt(1)
    v_pk_fma_f32 v[128:129], v[16:17], v[64:65], v[128:129] op_sel_hi:[1,0,1]
    v_pk_fma_f32 v[144:145], v[24:25], v[64:65], v[144:145] op_sel_hi:[1,0,1]
    v_pk_fma_f32 v[130:131], v[18:19], v[64:65], v[130:131] op_sel_hi:[1,0,1]
    v_pk_fma_f32 v[146:147], v[26:27], v[64:65], v[146:147] op_sel_hi:[1,0,1]
    v_pk_fma_f32 v[136:137], v[20:21], v[64:65], v[136:137] op_sel_hi:[1,0,1]
    v_pk_fma_f32 v[152:153], v[28:29], v[64:65], v[152:153] op_sel_hi:[1,0,1]
    v_pk_fma_f32 v[138:139], v[22:23], v[64:65], v[138:139] op_sel_hi:[1,0,1]
    v_pk_fma_f32 v[154:155], v[30:31], v[64:65], v[154:155] op_sel_hi:[1,0,1]
    v_pk_mul_f32 v[72:73], v[64:65], v[128:129] op_sel:[1,0] op_sel_hi:[1,1]
    v_pk_mul_f32 v[76:77], v[64:65], v[144:145] op_sel:[1,0] op_sel_hi:[1,1]
    v_pk_mul_f32 v[74:75], v[64:65], v[130:131] op_sel:[1,0] op_sel_hi:[1,1]
    v_pk_mul_f32 v[78:79], v[64:65], v[146:147] op_sel:[1,0] op_sel_hi:[1,1]
    v_exp_f32 v72, v72
    v_exp_f32 v76, v76
    v_exp_f32 v73, v73
    v_exp_f32 v77, v77
    v_exp_f32 v74, v74
    v_exp_f32 v78, v78
    v_exp_f32 v75, v75
    v_exp_f32 v79, v79
    v_pk_mul_f32 v[128:129], v[128:129], v[136:137]
    v_pk_mul_f32 v[144:145], v[144:145], v[152:153]
    v_pk_mul_f32 v[130:131], v[130:131], v[138:139]
    v_pk_mul_f32 v[146:147], v[146:147], v[154:155]
    v_pk_fma_f32 v[72:73], v[72:73], v[66:67], v[66:67] op_sel_hi:[1,0,0]
    v_pk_fma_f32 v[76:77], v[76:77], v[66:67], v[66:67] op_sel_hi:[1,0,0]
    v_pk_fma_f32 v[74:75], v[74:75], v[66:67], v[66:67] op_sel_hi:[1,0,0]
    v_pk_fma_f32 v[78:79], v[78:79], v[66:67], v[66:67] op_sel_hi:[1,0,0]
    v_rcp_f32 v72, v72
    v_rcp_f32 v76, v76
    v_rcp_f32 v73, v73
    v_rcp_f32 v77, v77
    v_rcp_f32 v74, v74
    v_rcp_f32 v78, v78
    v_rcp_f32 v75, v75
    v_rcp_f32 v79, v79
    v_pk_mul_f32 v[128:129], v[128:129], v[72:73]
    v_pk_mul_f32 v[144:145], v[144:145], v[76:77]
    v_pk_mul_f32 v[130:131], v[130:131], v[74:75]
    v_pk_mul_f32 v[146:147], v[146:147], v[78:79]
    v_cvt_pk_bf16_f32 v96, v128, v129
    v_cvt_pk_bf16_f32 v98, v144, v145
    v_cvt_pk_bf16_f32 v97, v130, v131
    v_cvt_pk_bf16_f32 v99, v146, v147
    buffer_store_dwordx4 v[96:99], v7, s[28:31], s52 offen offset:0 sc1
    s_waitcnt lgkmcnt(0)
    v_pk_fma_f32 v[132:133], v[16:17], v[68:69], v[132:133] op_sel_hi:[1,0,1]
    v_pk_fma_f32 v[148:149], v[24:25], v[68:69], v[148:149] op_sel_hi:[1,0,1]
    v_pk_fma_f32 v[134:135], v[18:19], v[68:69], v[134:135] op_sel_hi:[1,0,1]
    v_pk_fma_f32 v[150:151], v[26:27], v[68:69], v[150:151] op_sel_hi:[1,0,1]
    v_pk_fma_f32 v[140:141], v[20:21], v[68:69], v[140:141] op_sel_hi:[1,0,1]
    v_pk_fma_f32 v[156:157], v[28:29], v[68:69], v[156:157] op_sel_hi:[1,0,1]
    v_pk_fma_f32 v[142:143], v[22:23], v[68:69], v[142:143] op_sel_hi:[1,0,1]
    v_pk_fma_f32 v[158:159], v[30:31], v[68:69], v[158:159] op_sel_hi:[1,0,1]
    v_pk_mul_f32 v[80:81], v[68:69], v[132:133] op_sel:[1,0] op_sel_hi:[1,1]
    v_pk_mul_f32 v[84:85], v[68:69], v[148:149] op_sel:[1,0] op_sel_hi:[1,1]
    v_pk_mul_f32 v[82:83], v[68:69], v[134:135] op_sel:[1,0] op_sel_hi:[1,1]
    v_pk_mul_f32 v[86:87], v[68:69], v[150:151] op_sel:[1,0] op_sel_hi:[1,1]
    v_exp_f32 v80, v80
    v_exp_f32 v84, v84
    v_exp_f32 v81, v81
    v_exp_f32 v85, v85
    v_exp_f32 v82, v82
    v_exp_f32 v86, v86
    v_exp_f32 v83, v83
    v_exp_f32 v87, v87
    v_pk_mul_f32 v[132:133], v[132:133], v[140:141]
    v_pk_mul_f32 v[148:149], v[148:149], v[156:157]
    v_pk_mul_f32 v[134:135], v[134:135], v[142:143]
    v_pk_mul_f32 v[150:151], v[150:151], v[158:159]
    v_pk_fma_f32 v[80:81], v[80:81], v[70:71], v[70:71] op_sel_hi:[1,0,0]
    v_pk_fma_f32 v[84:85], v[84:85], v[70:71], v[70:71] op_sel_hi:[1,0,0]
    v_pk_fma_f32 v[82:83], v[82:83], v[70:71], v[70:71] op_sel_hi:[1,0,0]
    v_pk_fma_f32 v[86:87], v[86:87], v[70:71], v[70:71] op_sel_hi:[1,0,0]
    v_rcp_f32 v80, v80
    v_rcp_f32 v84, v84
    v_rcp_f32 v81, v81
    v_rcp_f32 v85, v85
    v_rcp_f32 v82, v82
    v_rcp_f32 v86, v86
    v_rcp_f32 v83, v83
    v_rcp_f32 v87, v87
    v_pk_mul_f32 v[132:133], v[132:133], v[80:81]
    v_pk_mul_f32 v[148:149], v[148:149], v[84:85]
    v_pk_mul_f32 v[134:135], v[134:135], v[82:83]
    v_pk_mul_f32 v[150:151], v[150:151], v[86:87]
    v_cvt_pk_bf16_f32 v100, v132, v133
    v_cvt_pk_bf16_f32 v102, v148, v149
    v_cvt_pk_bf16_f32 v101, v134, v135
    v_cvt_pk_bf16_f32 v103, v150, v151
    buffer_store_dwordx4 v[100:103], v7, s[28:31], s53 offen offset:0 sc1
    v_pk_fma_f32 v[160:161], v[32:33], v[64:65], v[160:161] op_sel_hi:[1,0,1]
    v_pk_fma_f32 v[176:177], v[40:41], v[64:65], v[176:177] op_sel_hi:[1,0,1]
    v_pk_fma_f32 v[162:163], v[34:35], v[64:65], v[162:163] op_sel_hi:[1,0,1]
    v_pk_fma_f32 v[178:179], v[42:43], v[64:65], v[178:179] op_sel_hi:[1,0,1]
    v_pk_fma_f32 v[168:169], v[36:37], v[64:65], v[168:169] op_sel_hi:[1,0,1]
    v_pk_fma_f32 v[184:185], v[44:45], v[64:65], v[184:185] op_sel_hi:[1,0,1]
    v_pk_fma_f32 v[170:171], v[38:39], v[64:65], v[170:171] op_sel_hi:[1,0,1]
    v_pk_fma_f32 v[186:187], v[46:47], v[64:65], v[186:187] op_sel_hi:[1,0,1]
    v_pk_mul_f32 v[72:73], v[64:65], v[160:161] op_sel:[1,0] op_sel_hi:[1,1]
    v_pk_mul_f32 v[76:77], v[64:65], v[176:177] op_sel:[1,0] op_sel_hi:[1,1]
    v_pk_mul_f32 v[74:75], v[64:65], v[162:163] op_sel:[1,0] op_sel_hi:[1,1]
    v_pk_mul_f32 v[78:79], v[64:65], v[178:179] op_sel:[1,0] op_sel_hi:[1,1]
    v_exp_f32 v72, v72
    v_exp_f32 v76, v76
    v_exp_f32 v73, v73
    v_exp_f32 v77, v77
    v_exp_f32 v74, v74
    v_exp_f32 v78, v78
    v_exp_f32 v75, v75
    v_exp_f32 v79, v79
    v_pk_mul_f32 v[160:161], v[160:161], v[168:169]
    v_pk_mul_f32 v[176:177], v[176:177], v[184:185]
    v_pk_mul_f32 v[162:163], v[162:163], v[170:171]
    v_pk_mul_f32 v[178:179], v[178:179], v[186:187]
    v_pk_fma_f32 v[72:73], v[72:73], v[66:67], v[66:67] op_sel_hi:[1,0,0]
    v_pk_fma_f32 v[76:77], v[76:77], v[66:67], v[66:67] op_sel_hi:[1,0,0]
    v_pk_fma_f32 v[74:75], v[74:75], v[66:67], v[66:67] op_sel_hi:[1,0,0]
    v_pk_fma_f32 v[78:79], v[78:79], v[66:67], v[66:67] op_sel_hi:[1,0,0]
    v_rcp_f32 v72, v72
    v_rcp_f32 v76, v76
    v_rcp_f32 v73, v73
    v_rcp_f32 v77, v77
    v_rcp_f32 v74, v74
    v_rcp_f32 v78, v78
    v_rcp_f32 v75, v75
    v_rcp_f32 v79, v79
    v_pk_mul_f32 v[160:161], v[160:161], v[72:73]
    v_pk_mul_f32 v[176:177], v[176:177], v[76:77]
    v_pk_mul_f32 v[162:163], v[162:163], v[74:75]
    v_pk_mul_f32 v[178:179], v[178:179], v[78:79]
    v_cvt_pk_bf16_f32 v104, v160, v161
    v_cvt_pk_bf16_f32 v106, v176, v177
    v_cvt_pk_bf16_f32 v105, v162, v163
    v_cvt_pk_bf16_f32 v107, v178, v179
    buffer_store_dwordx4 v[104:107], v7, s[28:31], s52 offen offset:1024 sc1
    v_pk_fma_f32 v[164:165], v[32:33], v[68:69], v[164:165] op_sel_hi:[1,0,1]
    v_pk_fma_f32 v[180:181], v[40:41], v[68:69], v[180:181] op_sel_hi:[1,0,1]
    v_pk_fma_f32 v[166:167], v[34:35], v[68:69], v[166:167] op_sel_hi:[1,0,1]
    v_pk_fma_f32 v[182:183], v[42:43], v[68:69], v[182:183] op_sel_hi:[1,0,1]
    v_pk_fma_f32 v[172:173], v[36:37], v[68:69], v[172:173] op_sel_hi:[1,0,1]
    v_pk_fma_f32 v[188:189], v[44:45], v[68:69], v[188:189] op_sel_hi:[1,0,1]
    v_pk_fma_f32 v[174:175], v[38:39], v[68:69], v[174:175] op_sel_hi:[1,0,1]
    v_pk_fma_f32 v[190:191], v[46:47], v[68:69], v[190:191] op_sel_hi:[1,0,1]
    v_pk_mul_f32 v[80:81], v[68:69], v[164:165] op_sel:[1,0] op_sel_hi:[1,1]
    v_pk_mul_f32 v[84:85], v[68:69], v[180:181] op_sel:[1,0] op_sel_hi:[1,1]
    v_pk_mul_f32 v[82:83], v[68:69], v[166:167] op_sel:[1,0] op_sel_hi:[1,1]
    v_pk_mul_f32 v[86:87], v[68:69], v[182:183] op_sel:[1,0] op_sel_hi:[1,1]
    v_exp_f32 v80, v80
    v_exp_f32 v84, v84
    v_exp_f32 v81, v81
    v_exp_f32 v85, v85
    v_exp_f32 v82, v82
    v_exp_f32 v86, v86
    v_exp_f32 v83, v83
    v_exp_f32 v87, v87
    v_pk_mul_f32 v[164:165], v[164:165], v[172:173]
    v_pk_mul_f32 v[180:181], v[180:181], v[188:189]
    v_pk_mul_f32 v[166:167], v[166:167], v[174:175]
    v_pk_mul_f32 v[182:183], v[182:183], v[190:191]
    v_pk_fma_f32 v[80:81], v[80:81], v[70:71], v[70:71] op_sel_hi:[1,0,0]
    v_pk_fma_f32 v[84:85], v[84:85], v[70:71], v[70:71] op_sel_hi:[1,0,0]
    v_pk_fma_f32 v[82:83], v[82:83], v[70:71], v[70:71] op_sel_hi:[1,0,0]
    v_pk_fma_f32 v[86:87], v[86:87], v[70:71], v[70:71] op_sel_hi:[1,0,0]
    v_rcp_f32 v80, v80
    v_rcp_f32 v84, v84
    v_rcp_f32 v81, v81
    v_rcp_f32 v85, v85
    v_rcp_f32 v82, v82
    v_rcp_f32 v86, v86
    v_rcp_f32 v83, v83
    v_rcp_f32 v87, v87
    v_pk_mul_f32 v[164:165], v[164:165], v[80:81]
    v_pk_mul_f32 v[180:181], v[180:181], v[84:85]
    v_pk_mul_f32 v[166:167], v[166:167], v[82:83]
    v_pk_mul_f32 v[182:183], v[182:183], v[86:87]
    v_cvt_pk_bf16_f32 v108, v164, v165
    v_cvt_pk_bf16_f32 v110, v180, v181
    v_cvt_pk_bf16_f32 v109, v166, v167
    v_cvt_pk_bf16_f32 v111, v182, v183
    buffer_store_dwordx4 v[108:111], v7, s[28:31], s53 offen offset:1024 sc1
    v_pk_fma_f32 v[192:193], v[48:49], v[64:65], v[192:193] op_sel_hi:[1,0,1]
    v_pk_fma_f32 v[208:209], v[56:57], v[64:65], v[208:209] op_sel_hi:[1,0,1]
    v_pk_fma_f32 v[194:195], v[50:51], v[64:65], v[194:195] op_sel_hi:[1,0,1]
    v_pk_fma_f32 v[210:211], v[58:59], v[64:65], v[210:211] op_sel_hi:[1,0,1]
    v_pk_fma_f32 v[200:201], v[52:53], v[64:65], v[200:201] op_sel_hi:[1,0,1]
    v_pk_fma_f32 v[216:217], v[60:61], v[64:65], v[216:217] op_sel_hi:[1,0,1]
    v_pk_fma_f32 v[202:203], v[54:55], v[64:65], v[202:203] op_sel_hi:[1,0,1]
    v_pk_fma_f32 v[218:219], v[62:63], v[64:65], v[218:219] op_sel_hi:[1,0,1]
    v_pk_mul_f32 v[72:73], v[64:65], v[192:193] op_sel:[1,0] op_sel_hi:[1,1]
    v_pk_mul_f32 v[76:77], v[64:65], v[208:209] op_sel:[1,0] op_sel_hi:[1,1]
    v_pk_mul_f32 v[74:75], v[64:65], v[194:195] op_sel:[1,0] op_sel_hi:[1,1]
    v_pk_mul_f32 v[78:79], v[64:65], v[210:211] op_sel:[1,0] op_sel_hi:[1,1]
    v_exp_f32 v72, v72
    v_exp_f32 v76, v76
    v_exp_f32 v73, v73
    v_exp_f32 v77, v77
    v_exp_f32 v74, v74
    v_exp_f32 v78, v78
    v_exp_f32 v75, v75
    v_exp_f32 v79, v79
    v_pk_mul_f32 v[192:193], v[192:193], v[200:201]
    v_pk_mul_f32 v[208:209], v[208:209], v[216:217]
    v_pk_mul_f32 v[194:195], v[194:195], v[202:203]
    v_pk_mul_f32 v[210:211], v[210:211], v[218:219]
    v_pk_fma_f32 v[72:73], v[72:73], v[66:67], v[66:67] op_sel_hi:[1,0,0]
    v_pk_fma_f32 v[76:77], v[76:77], v[66:67], v[66:67] op_sel_hi:[1,0,0]
    v_pk_fma_f32 v[74:75], v[74:75], v[66:67], v[66:67] op_sel_hi:[1,0,0]
    v_pk_fma_f32 v[78:79], v[78:79], v[66:67], v[66:67] op_sel_hi:[1,0,0]
    v_rcp_f32 v72, v72
    v_rcp_f32 v76, v76
    v_rcp_f32 v73, v73
    v_rcp_f32 v77, v77
    v_rcp_f32 v74, v74
    v_rcp_f32 v78, v78
    v_rcp_f32 v75, v75
    v_rcp_f32 v79, v79
    v_pk_mul_f32 v[192:193], v[192:193], v[72:73]
    v_pk_mul_f32 v[208:209], v[208:209], v[76:77]
    v_pk_mul_f32 v[194:195], v[194:195], v[74:75]
    v_pk_mul_f32 v[210:211], v[210:211], v[78:79]
    v_cvt_pk_bf16_f32 v112, v192, v193
    v_cvt_pk_bf16_f32 v114, v208, v209
    v_cvt_pk_bf16_f32 v113, v194, v195
    v_cvt_pk_bf16_f32 v115, v210, v211
    buffer_store_dwordx4 v[112:115], v7, s[28:31], s52 offen offset:2048 sc1
    v_pk_fma_f32 v[196:197], v[48:49], v[68:69], v[196:197] op_sel_hi:[1,0,1]
    v_pk_fma_f32 v[212:213], v[56:57], v[68:69], v[212:213] op_sel_hi:[1,0,1]
    v_pk_fma_f32 v[198:199], v[50:51], v[68:69], v[198:199] op_sel_hi:[1,0,1]
    v_pk_fma_f32 v[214:215], v[58:59], v[68:69], v[214:215] op_sel_hi:[1,0,1]
    v_pk_fma_f32 v[204:205], v[52:53], v[68:69], v[204:205] op_sel_hi:[1,0,1]
    v_pk_fma_f32 v[220:221], v[60:61], v[68:69], v[220:221] op_sel_hi:[1,0,1]
    v_pk_fma_f32 v[206:207], v[54:55], v[68:69], v[206:207] op_sel_hi:[1,0,1]
    v_pk_fma_f32 v[222:223], v[62:63], v[68:69], v[222:223] op_sel_hi:[1,0,1]
    v_pk_mul_f32 v[80:81], v[68:69], v[196:197] op_sel:[1,0] op_sel_hi:[1,1]
    v_pk_mul_f32 v[84:85], v[68:69], v[212:213] op_sel:[1,0] op_sel_hi:[1,1]
    v_pk_mul_f32 v[82:83], v[68:69], v[198:199] op_sel:[1,0] op_sel_hi:[1,1]
    v_pk_mul_f32 v[86:87], v[68:69], v[214:215] op_sel:[1,0] op_sel_hi:[1,1]
    v_exp_f32 v80, v80
    v_exp_f32 v84, v84
    v_exp_f32 v81, v81
    v_exp_f32 v85, v85
    v_exp_f32 v82, v82
    v_exp_f32 v86, v86
    v_exp_f32 v83, v83
    v_exp_f32 v87, v87
    v_pk_mul_f32 v[196:197], v[196:197], v[204:205]
    v_pk_mul_f32 v[212:213], v[212:213], v[220:221]
    v_pk_mul_f32 v[198:199], v[198:199], v[206:207]
    v_pk_mul_f32 v[214:215], v[214:215], v[222:223]
    v_pk_fma_f32 v[80:81], v[80:81], v[70:71], v[70:71] op_sel_hi:[1,0,0]
    v_pk_fma_f32 v[84:85], v[84:85], v[70:71], v[70:71] op_sel_hi:[1,0,0]
    v_pk_fma_f32 v[82:83], v[82:83], v[70:71], v[70:71] op_sel_hi:[1,0,0]
    v_pk_fma_f32 v[86:87], v[86:87], v[70:71], v[70:71] op_sel_hi:[1,0,0]
    v_rcp_f32 v80, v80
    v_rcp_f32 v84, v84
    v_rcp_f32 v81, v81
    v_rcp_f32 v85, v85
    v_rcp_f32 v82, v82
    v_rcp_f32 v86, v86
    v_rcp_f32 v83, v83
    v_rcp_f32 v87, v87
    v_pk_mul_f32 v[196:197], v[196:197], v[80:81]
    v_pk_mul_f32 v[212:213], v[212:213], v[84:85]
    v_pk_mul_f32 v[198:199], v[198:199], v[82:83]
    v_pk_mul_f32 v[214:215], v[214:215], v[86:87]
    v_cvt_pk_bf16_f32 v116, v196, v197
    v_cvt_pk_bf16_f32 v118, v212, v213
    v_cvt_pk_bf16_f32 v117, v198, v199
    v_cvt_pk_bf16_f32 v119, v214, v215
    buffer_store_dwordx4 v[116:119], v7, s[28:31], s53 offen offset:2048 sc1
    s_waitcnt vmcnt(0)
    s_barrier
    s_endpgm
k3_help:
    s_sub_u32 s41, s20, 4
    s_lshl_b32 s42, s41, 1
    v_lshrrev_b32 v1, 4, v0
    v_bfe_u32 v2, v0, 1, 3
    v_and_b32 v3, 1, v0
    v_lshlrev_b32 v7, 8, v1
    v_lshl_add_u32 v7, v3, 4, v7
    v_add_u32 v6, 0, v1
    v_xor_b32 v6, v6, v2
    v_lshl_add_u32 v12, v6, 5, v7
    v_add_u32 v6, 4, v1
    v_xor_b32 v6, v6, v2
    v_lshl_add_u32 v13, v6, 5, v7
    v_lshlrev_b32 v14, 4, v0
    s_mul_i32 s50, s41, 2048
    s_mul_i32 s43, s22, 163840
    s_add_u32 s50, s50, s43
    s_mul_i32 s52, s21, 12
    s_mul_i32 s43, s41, 3
    s_add_u32 s52, s52, s43
    s_lshl_b32 s52, s52, 10
    s_lshl_b32 s54, s41, 11
    s_mul_i32 s55, s41, 3072
    s_add_u32 s55, s55, 8192
    s_waitcnt lgkmcnt(0)
    s_add_u32 s24, s16, 8388608
    s_addc_u32 s25, s17, 0
    s_mov_b32 s26, 2621440
    s_mov_b32 s27, 0x20000
    s_add_u32 s28, s16, 20971520
    s_addc_u32 s29, s17, 0
    s_mov_b32 s30, 3932160
    s_mov_b32 s31, 0x20000
    s_add_u32 m0, s54, 0
    s_add_u32 s63, s55, 0
    buffer_load_dwordx4 v12, s[24:27], s50 offen lds
    buffer_load_dwordx4 v13, s[24:27], s50 offen offset:1024 lds
    s_mov_b32 m0, s63
    s_add_u32 s50, s50, 8192
    buffer_load_dwordx4 v14, s[28:31], s52 offen lds
    buffer_load_dwordx4 v14, s[28:31], s52 offen offset:1024 lds
    buffer_load_dwordx4 v14, s[28:31], s52 offen offset:2048 lds
    s_add_u32 s52, s52, 196608
    s_add_u32 m0, s54, 20480
    s_add_u32 s63, s55, 20480
    buffer_load_dwordx4 v12, s[24:27], s50 offen lds
    buffer_load_dwordx4 v13, s[24:27], s50 offen offset:1024 lds
    s_mov_b32 m0, s63
    s_add_u32 s50, s50, 8192
    buffer_load_dwordx4 v14, s[28:31], s52 offen lds
    buffer_load_dwordx4 v14, s[28:31], s52 offen offset:1024 lds
    buffer_load_dwordx4 v14, s[28:31], s52 offen offset:2048 lds
    s_add_u32 s52, s52, 196608
    s_add_u32 m0, s54, 40960
    s_add_u32 s63, s55, 40960
    buffer_load_dwordx4 v12, s[24:27], s50 offen lds
    buffer_load_dwordx4 v13, s[24:27], s50 offen offset:1024 lds
    s_mov_b32 m0, s63
    s_add_u32 s50, s50, 8192
    buffer_load_dwordx4 v14, s[28:31], s52 offen lds
    buffer_load_dwordx4 v14, s[28:31], s52 offen offset:1024 lds
    buffer_load_dwordx4 v14, s[28:31], s52 offen offset:2048 lds
    s_add_u32 s52, s52, 196608
    v_lshrrev_b32 v1, 4, v0
    v_bfe_u32 v2, v0, 2, 2
    v_bfe_u32 v3, v0, 4, 1
    v_lshl_add_u32 v2, v3, 2, v2
    v_and_b32 v3, 3, v0
    v_lshrrev_b32 v4, 1, v1
    v_lshlrev_b32 v4, 12, v4
    v_lshl_add_u32 v4, v2, 8, v4
    v_lshl_add_u32 v4, v3, 3, v4
    s_add_u32 s43, s42, 0
    v_xor_b32 v8, s43, v2
    v_lshl_add_u32 v8, v8, 5, v4
    s_add_u32 s43, s42, 1
    v_xor_b32 v9, s43, v2
    v_lshl_add_u32 v9, v9, 5, v4
    v_mov_b32 v176, 0
    v_mov_b32 v177, 0
    v_mov_b32 v178, 0
    v_mov_b32 v179, 0
    v_mov_b32 v168, 0
    v_mov_b32 v169, 0
    v_mov_b32 v170, 0
    v_mov_b32 v171, 0
    v_mov_b32 v172, 0
    v_mov_b32 v173, 0
    v_mov_b32 v174, 0
    v_mov_b32 v175, 0
    s_mov_b32 s46, 0x3f803f80
    s_mov_b32 s48, 0xffff0000
    s_mov_b32 s60, 61440
    s_waitcnt vmcnt(10)
    s_barrier
    s_mov_b32 s57, 0
k3h_loop:
    s_add_u32 m0, s54, s60
    s_add_u32 s63, s55, s60
    buffer_load_dwordx4 v12, s[24:27], s50 offen lds
    buffer_load_dwordx4 v13, s[24:27], s50 offen offset:1024 lds
    s_mov_b32 m0, s63
    s_add_u32 s50, s50, 8192
    buffer_load_dwordx4 v14, s[28:31], s52 offen lds
    buffer_load_dwordx4 v14, s[28:31], s52 offen offset:1024 lds
    buffer_load_dwordx4 v14, s[28:31], s52 offen offset:2048 lds
    s_add_u32 s52, s52, 196608
    s_add_u32 s60, s60, 20480
    s_cmp_eq_u32 s60, 81920
    s_cselect_b32 s60, 0, s60
    v_add_u32 v10, s60, v8
    ds_read_b64_tr_b16 v[160:161], v10
    ds_read_b64_tr_b16 v[162:163], v10 offset:2048
    v_add_u32 v11, s60, v9
    ds_read_b64_tr_b16 v[164:165], v11
    ds_read_b64_tr_b16 v[166:167], v11 offset:2048
    v_dot2_f32_bf16 v176, v168, s46, v176
    v_dot2_f32_bf16 v177, v168, v168, v177
    v_dot2_f32_bf16 v178, v172, s46, v178
    v_dot2_f32_bf16 v179, v172, v172, v179
    v_dot2_f32_bf16 v176, v169, s46, v176
    v_dot2_f32_bf16 v177, v169, v169, v177
    v_dot2_f32_bf16 v178, v173, s46, v178
    v_dot2_f32_bf16 v179, v173, v173, v179
    v_dot2_f32_bf16 v176, v170, s46, v176
    v_dot2_f32_bf16 v177, v170, v170, v177
    v_dot2_f32_bf16 v178, v174, s46, v178
    v_dot2_f32_bf16 v179, v174, v174, v179
    v_dot2_f32_bf16 v176, v171, s46, v176
    v_dot2_f32_bf16 v177, v171, v171, v177
    v_dot2_f32_bf16 v178, v175, s46, v178
    v_dot2_f32_bf16 v179, v175, v175, v179
    s_waitcnt vmcnt(10) lgkmcnt(0)
    s_barrier
    s_add_u32 m0, s54, s60
    s_add_u32 s63, s55, s60
    buffer_load_dwordx4 v12, s[24:27], s50 offen lds
    buffer_load_dwordx4 v13, s[24:27], s50 offen offset:1024 lds
    s_mov_b32 m0, s63
    s_add_u32 s50, s50, 8192
    buffer_load_dwordx4 v14, s[28:31], s52 offen lds
    buffer_load_dwordx4 v14, s[28:31], s52 offen offset:1024 lds
    buffer_load_dwordx4 v14, s[28:31], s52 offen offset:2048 lds
    s_add_u32 s52, s52, 196608
    s_add_u32 s60, s60, 20480
    s_cmp_eq_u32 s60, 81920
    s_cselect_b32 s60, 0, s60
    v_add_u32 v10, s60, v8
    ds_read_b64_tr_b16 v[168:169], v10
    ds_read_b64_tr_b16 v[170:171], v10 offset:2048
    v_add_u32 v11, s60, v9
    ds_read_b64_tr_b16 v[172:173], v11
    ds_read_b64_tr_b16 v[174:175], v11 offset:2048
    v_dot2_f32_bf16 v176, v160, s46, v176
    v_dot2_f32_bf16 v177, v160, v160, v177
    v_dot2_f32_bf16 v178, v164, s46, v178
    v_dot2_f32_bf16 v179, v164, v164, v179
    v_dot2_f32_bf16 v176, v161, s46, v176
    v_dot2_f32_bf16 v177, v161, v161, v177
    v_dot2_f32_bf16 v178, v165, s46, v178
    v_dot2_f32_bf16 v179, v165, v165, v179
    v_dot2_f32_bf16 v176, v162, s46, v176
    v_dot2_f32_bf16 v177, v162, v162, v177
    v_dot2_f32_bf16 v178, v166, s46, v178
    v_dot2_f32_bf16 v179, v166, v166, v179
    v_dot2_f32_bf16 v176, v163, s46, v176
    v_dot2_f32_bf16 v177, v163, v163, v177
    v_dot2_f32_bf16 v178, v167, s46, v178
    v_dot2_f32_bf16 v179, v167, v167, v179
    s_waitcnt vmcnt(10) lgkmcnt(0)
    s_barrier
    s_add_u32 s57, s57, 1
    s_cmp_lt_u32 s57, 8
    s_cbranch_scc1 k3h_loop
    s_add_u32 m0, s54, s60
    s_add_u32 s63, s55, s60
    buffer_load_dwordx4 v12, s[24:27], s50 offen lds
    buffer_load_dwordx4 v13, s[24:27], s50 offen offset:1024 lds
    s_mov_b32 m0, s63
    s_add_u32 s50, s50, 8192
    buffer_load_dwordx4 v14, s[28:31], s52 offen lds
    buffer_load_dwordx4 v14, s[28:31], s52 offen offset:1024 lds
    buffer_load_dwordx4 v14, s[28:31], s52 offen offset:2048 lds
    s_add_u32 s52, s52, 196608
    s_add_u32 s60, s60, 20480
    s_cmp_eq_u32 s60, 81920
    s_cselect_b32 s60, 0, s60
    v_add_u32 v10, s60, v8
    ds_read_b64_tr_b16 v[160:161], v10
    ds_read_b64_tr_b16 v[162:163], v10 offset:2048
    v_add_u32 v11, s60, v9
    ds_read_b64_tr_b16 v[164:165], v11
    ds_read_b64_tr_b16 v[166:167], v11 offset:2048
    v_dot2_f32_bf16 v176, v168, s46, v176
    v_dot2_f32_bf16 v177, v168, v168, v177
    v_dot2_f32_bf16 v178, v172, s46, v178
    v_dot2_f32_bf16 v179, v172, v172, v179
    v_dot2_f32_bf16 v176, v169, s46, v176
    v_dot2_f32_bf16 v177, v169, v169, v177
    v_dot2_f32_bf16 v178, v173, s46, v178
    v_dot2_f32_bf16 v179, v173, v173, v179
    v_dot2_f32_bf16 v176, v170, s46, v176
    v_dot2_f32_bf16 v177, v170, v170, v177
    v_dot2_f32_bf16 v178, v174, s46, v178
    v_dot2_f32_bf16 v179, v174, v174, v179
    v_dot2_f32_bf16 v176, v171, s46, v176
    v_dot2_f32_bf16 v177, v171, v171, v177
    v_dot2_f32_bf16 v178, v175, s46, v178
    v_dot2_f32_bf16 v179, v175, v175, v179
    s_waitcnt vmcnt(10) lgkmcnt(0)
    s_barrier
    s_mov_b32 s23, s22
    s_lshl_b32 s22, s22, 1
    s_bfe_u32 s43, s21, 0x10002
    s_add_u32 s22, s22, s43
    s_lshr_b32 s43, s21, 3
    s_lshl_b32 s43, s43, 2
    s_and_b32 s47, s21, 3
    s_add_u32 s47, s47, s43
    v_lshlrev_b32 v4, 4, v0
    v_add_u32 v5, 4096, v4
    s_mul_i32 s56, s41, 480
    s_mul_i32 s44, s47, 5
    s_add_u32 s56, s56, s44
    s_lshl_b32 s56, s56, 10
    s_add_u32 s36, s16, 25165824
    s_addc_u32 s37, s17, 0
    s_mov_b32 s38, 1966080
    s_mov_b32 s39, 0x20000
    s_mul_i32 s61, s41, 5120
    s_add_u32 s61, s61, 81920
    s_mul_i32 s64, s41, 15360
    s_add_u32 s51, s56, 0
    buffer_load_dwordx4 v[16:19], v4, s[36:39], s51 offen
    buffer_load_dwordx4 v[20:23], v4, s[36:39], s51 offen offset:1024
    buffer_load_dwordx4 v[24:27], v4, s[36:39], s51 offen offset:2048
    buffer_load_dwordx4 v[28:31], v4, s[36:39], s51 offen offset:3072
    buffer_load_dwordx4 v[32:35], v5, s[36:39], s51 offen
    s_add_u32 s60, s60, 20480
    s_cmp_eq_u32 s60, 81920
    s_cselect_b32 s60, 0, s60
    v_add_u32 v10, s60, v8
    ds_read_b64_tr_b16 v[168:169], v10
    ds_read_b64_tr_b16 v[170:171], v10 offset:2048
    v_add_u32 v11, s60, v9
    ds_read_b64_tr_b16 v[172:173], v11
    ds_read_b64_tr_b16 v[174:175], v11 offset:2048
    v_dot2_f32_bf16 v176, v160, s46, v176
    v_dot2_f32_bf16 v177, v160, v160, v177
    v_dot2_f32_bf16 v178, v164, s46, v178
    v_dot2_f32_bf16 v179, v164, v164, v179
    v_dot2_f32_bf16 v176, v161, s46, v176
    v_dot2_f32_bf16 v177, v161, v161, v177
    v_dot2_f32_bf16 v178, v165, s46, v178
    v_dot2_f32_bf16 v179, v165, v165, v179
    v_dot2_f32_bf16 v176, v162, s46, v176
    v_dot2_f32_bf16 v177, v162, v162, v177
    v_dot2_f32_bf16 v178, v166, s46, v178
    v_dot2_f32_bf16 v179, v166, v166, v179
    v_dot2_f32_bf16 v176, v163, s46, v176
    v_dot2_f32_bf16 v177, v163, v163, v177
    v_dot2_f32_bf16 v178, v167, s46, v178
    v_dot2_f32_bf16 v179, v167, v167, v179
    s_waitcnt vmcnt(10) lgkmcnt(0)
    s_barrier
    s_add_u32 s51, s56, 40960
    buffer_load_dwordx4 v[36:39], v4, s[36:39], s51 offen
    buffer_load_dwordx4 v[40:43], v4, s[36:39], s51 offen offset:1024
    buffer_load_dwordx4 v[44:47], v4, s[36:39], s51 offen offset:2048
    buffer_load_dwordx4 v[48:51], v4, s[36:39], s51 offen offset:3072
    buffer_load_dwordx4 v[52:55], v5, s[36:39], s51 offen
    s_add_u32 s60, s60, 20480
    s_cmp_eq_u32 s60, 81920
    s_cselect_b32 s60, 0, s60
    v_add_u32 v10, s60, v8
    ds_read_b64_tr_b16 v[160:161], v10
    ds_read_b64_tr_b16 v[162:163], v10 offset:2048
    v_add_u32 v11, s60, v9
    ds_read_b64_tr_b16 v[164:165], v11
    ds_read_b64_tr_b16 v[166:167], v11 offset:2048
    v_dot2_f32_bf16 v176, v168, s46, v176
    v_dot2_f32_bf16 v177, v168, v168, v177
    v_dot2_f32_bf16 v178, v172, s46, v178
    v_dot2_f32_bf16 v179, v172, v172, v179
    v_dot2_f32_bf16 v176, v169, s46, v176
    v_dot2_f32_bf16 v177, v169, v169, v177
    v_dot2_f32_bf16 v178, v173, s46, v178
    v_dot2_f32_bf16 v179, v173, v173, v179
    v_dot2_f32_bf16 v176, v170, s46, v176
    v_dot2_f32_bf16 v177, v170, v170, v177
    v_dot2_f32_bf16 v178, v174, s46, v178
    v_dot2_f32_bf16 v179, v174, v174, v179
    v_dot2_f32_bf16 v176, v171, s46, v176
    v_dot2_f32_bf16 v177, v171, v171, v177
    v_dot2_f32_bf16 v178, v175, s46, v178
    v_dot2_f32_bf16 v179, v175, v175, v179
    s_waitcnt vmcnt(10) lgkmcnt(0)
    s_barrier
    s_add_u32 s51, s56, 81920
    buffer_load_dwordx4 v[56:59], v4, s[36:39], s51 offen
    buffer_load_dwordx4 v[60:63], v4, s[36:39], s51 offen offset:1024
    buffer_load_dwordx4 v[64:67], v4, s[36:39], s51 offen offset:2048
    buffer_load_dwordx4 v[68:71], v4, s[36:39], s51 offen offset:3072
    buffer_load_dwordx4 v[72:75], v5, s[36:39], s51 offen
    s_add_u32 s60, s60, 20480
    s_cmp_eq_u32 s60, 81920
    s_cselect_b32 s60, 0, s60
    v_add_u32 v10, s60, v8
    ds_read_b64_tr_b16 v[168:169], v10
    ds_read_b64_tr_b16 v[170:171], v10 offset:2048
    v_add_u32 v11, s60, v9
    ds_read_b64_tr_b16 v[172:173], v11
    ds_read_b64_tr_b16 v[174:175], v11 offset:2048
    v_dot2_f32_bf16 v176, v160, s46, v176
    v_dot2_f32_bf16 v177, v160, v160, v177
    v_dot2_f32_bf16 v178, v164, s46, v178
    v_dot2_f32_bf16 v179, v164, v164, v179
    v_dot2_f32_bf16 v176, v161, s46, v176
    v_dot2_f32_bf16 v177, v161, v161, v177
    v_dot2_f32_bf16 v178, v165, s46, v178
    v_dot2_f32_bf16 v179, v165, v165, v179
    v_dot2_f32_bf16 v176, v162, s46, v176
    v_dot2_f32_bf16 v177, v162, v162, v177
    v_dot2_f32_bf16 v178, v166, s46, v178
    v_dot2_f32_bf16 v179, v166, v166, v179
    v_dot2_f32_bf16 v176, v163, s46, v176
    v_dot2_f32_bf16 v177, v163, v163, v177
    v_dot2_f32_bf16 v178, v167, s46, v178
    v_dot2_f32_bf16 v179, v167, v167, v179
    s_waitcnt lgkmcnt(0)
    v_dot2_f32_bf16 v176, v168, s46, v176
    v_dot2_f32_bf16 v177, v168, v168, v177
    v_dot2_f32_bf16 v178, v172, s46, v178
    v_dot2_f32_bf16 v179, v172, v172, v179
    v_dot2_f32_bf16 v176, v169, s46, v176
    v_dot2_f32_bf16 v177, v169, v169, v177
    v_dot2_f32_bf16 v178, v173, s46, v178
    v_dot2_f32_bf16 v179, v173, v173, v179
    v_dot2_f32_bf16 v176, v170, s46, v176
    v_dot2_f32_bf16 v177, v170, v170, v177
    v_dot2_f32_bf16 v178, v174, s46, v178
    v_dot2_f32_bf16 v179, v174, v174, v179
    v_dot2_f32_bf16 v176, v171, s46, v176
    v_dot2_f32_bf16 v177, v171, v171, v177
    v_dot2_f32_bf16 v178, v175, s46, v178
    v_dot2_f32_bf16 v179, v175, v175, v179
    v_mov_b32 v160, v176
    v_mov_b32 v161, v177
    v_mov_b32 v162, v178
    v_mov_b32 v163, v179
    v_permlane16_swap_b32 v176, v160
    v_permlane16_swap_b32 v177, v161
    v_permlane16_swap_b32 v178, v162
    v_permlane16_swap_b32 v179, v163
    v_add_f32 v176, v176, v160
    v_add_f32 v177, v177, v161
    v_add_f32 v178, v178, v162
    v_add_f32 v179, v179, v163
    v_mov_b32 v160, v176
    v_mov_b32 v161, v177
    v_mov_b32 v162, v178
    v_mov_b32 v163, v179
    v_permlane32_swap_b32 v176, v160
    v_permlane32_swap_b32 v177, v161
    v_permlane32_swap_b32 v178, v162
    v_permlane32_swap_b32 v179, v163
    v_add_f32 v176, v176, v160
    v_add_f32 v177, v177, v161
    v_add_f32 v178, v178, v162
    v_add_f32 v179, v179, v163
    v_cmp_le_u32 vcc, 32, v0
    s_nop 1
    v_cndmask_b32 v176, v176, v178, vcc
    v_cndmask_b32 v177, v177, v179, vcc
    s_lshl_b32 s43, s41, 9
    s_add_u32 s43, s43, 161792
    v_and_b32 v3, 15, v0
    v_lshlrev_b32 v3, 4, v3
    v_lshrrev_b32 v2, 5, v0
    v_lshl_add_u32 v3, v2, 8, v3
    v_add_u32 v3, s43, v3
    v_mul_f32 v176, 0x3acccccd, v176
    v_mul_f32 v177, 0x3acccccd, v177
    v_fma_f32 v177, -v176, v176, v177
    v_cvt_pk_bf16_f32 v184, v176, v177
    v_lshlrev_b32 v180, 16, v184
    v_and_b32 v184, s48, v184
    v_add_f32 v184, 0x3727c5ac, v184
    v_cvt_pk_bf16_f32 v184, v184, v184
    v_and_b32 v184, s48, v184
    v_sqrt_f32 v184, v184
    s_nop 0
    v_cvt_pk_bf16_f32 v184, v184, v184
    v_and_b32 v184, s48, v184
    v_rcp_f32 v181, v184
    v_mul_f32 v182, v184, v184
    v_mul_f32 v181, 0xbfb8aa3b, v181
    v_sub_f32 v180, 0, v180
    v_mov_b32 v183, 0
    ds_write_b128 v3, v[180:183]
    s_waitcnt lgkmcnt(0)
    s_barrier
    s_mul_i32 s43, s41, 12
    v_lshrrev_b32 v2, 3, v0
    v_lshlrev_b32 v2, 8, v2
    v_and_b32 v3, 7, v0
    v_lshl_add_u32 v10, v3, 4, v2
    s_mul_i32 s52, s47, 80
    s_mul_i32 s44, s41, 24
    s_add_u32 s52, s52, s44
    s_lshr_b32 s44, s22, 1
    s_mul_i32 s44, s44, 640
    s_add_u32 s52, s52, s44
    s_lshl_b32 s52, s52, 8
    s_and_b32 s44, s22, 1
    s_lshl_b32 s44, s44, 7
    s_add_u32 s52, s52, s44
    s_mul_i32 s53, s41, 3072
    s_add_u32 s44, s41, 0
    s_and_b32 s44, s44, 3
    s_mul_i32 s44, s44, 49152
    v_add_u32 v6, s44, v4
    s_add_u32 s44, s41, 1
    s_and_b32 s44, s44, 3
    s_mul_i32 s44, s44, 49152
    v_add_u32 v7, s44, v4
    s_add_u32 s44, s41, 2
    s_and_b32 s44, s44, 3
    s_mul_i32 s44, s44, 49152
    v_add_u32 v8, s44, v4
    s_add_u32 s44, s41, 3
    s_and_b32 s44, s44, 3
    s_mul_i32 s44, s44, 49152
    v_add_u32 v9, s44, v4
    s_mul_i32 s50, s22, 192
    s_add_u32 s50, s50, s43
    s_lshl_b32 s50, s50, 10
    s_add_u32 s32, s16, 19070976
    s_addc_u32 s33, s17, 0
    s_mov_b32 s34, 8192
    s_mov_b32 s35, 0x20000
    v_add_u32 v13, s61, v4
    v_add_u32 v14, s64, v4
    v_add_u32 v15, 61440, v13
    s_lshl_b32 s44, s23, 2
    s_lshr_b32 s45, s21, 2
    s_add_u32 s44, s44, s45
    s_lshl_b32 s44, s44, 7
    s_and_b32 s45, s21, 3
    s_lshl_b32 s45, s45, 2
    s_add_u32 s45, s45, s44
    s_lshr_b32 s44, s22, 1
    s_lshl_b32 s44, s44, 2
    s_add_u32 s44, s44, s41
    s_lshl_b32 s46, s44, 7
    v_mov_b32 v11, 0
    v_mov_b32 v12, 1
    s_add_u32 s51, s56, 122880
    buffer_load_dwordx4 v[76:79], v4, s[36:39], s51 offen
    buffer_load_dwordx4 v[80:83], v4, s[36:39], s51 offen offset:1024
    buffer_load_dwordx4 v[84:87], v4, s[36:39], s51 offen offset:2048
    buffer_load_dwordx4 v[88:91], v4, s[36:39], s51 offen offset:3072
    buffer_load_dwordx4 v[92:95], v5, s[36:39], s51 offen
    s_add_u32 s51, s56, 163840
    buffer_load_dwordx4 v[96:99], v4, s[36:39], s51 offen
    buffer_load_dwordx4 v[100:103], v4, s[36:39], s51 offen offset:1024
    buffer_load_dwordx4 v[104:107], v4, s[36:39], s51 offen offset:2048
    buffer_load_dwordx4 v[108:111], v4, s[36:39], s51 offen offset:3072
    buffer_load_dwordx4 v[112:115], v5, s[36:39], s51 offen
    s_add_u32 m0, s53, 61440
    s_nop 0
    buffer_load_dwordx4 v10, s[24:27], s52 offen lds
    s_add_u32 s52, s52, 2048
    s_add_u32 m0, s53, 62464
    s_nop 0
    buffer_load_dwordx4 v10, s[24:27], s52 offen lds
    s_add_u32 s52, s52, 2048
    s_add_u32 m0, s53, 63488
    s_nop 0
    buffer_load_dwordx4 v10, s[24:27], s52 offen lds
    s_add_u32 s52, s52, 2048
    s_barrier
    s_mov_b64 exec, 1
    s_cmp_lg_u32 s41, 0
    s_cbranch_scc1 g2_noflag
    buffer_store_dword v12, v11, s[32:35], s45 offen sc1
g2_noflag:
    s_mov_b64 exec, -1
    s_add_u32 s51, s56, 327680
    s_add_u32 m0, s61, 61440
    s_nop 0
    buffer_load_dwordx4 v4, s[36:39], s51 offen offset:2048 lds
    buffer_load_dwordx4 v4, s[36:39], s51 offen offset:3072 lds
    s_add_u32 m0, s61, 65536
    s_nop 0
    buffer_load_dwordx4 v5, s[36:39], s51 offen lds
    s_add_u32 s51, s56, 368640
    s_add_u32 m0, s64, 0
    s_nop 0
    buffer_load_dwordx4 v4, s[36:39], s51 offen lds
    buffer_load_dwordx4 v4, s[36:39], s51 offen offset:1024 lds
    buffer_load_dwordx4 v4, s[36:39], s51 offen offset:2048 lds
    buffer_load_dwordx4 v4, s[36:39], s51 offen offset:3072 lds
    s_add_u32 m0, s64, 4096
    s_nop 0
    buffer_load_dwordx4 v5, s[36:39], s51 offen lds
    s_add_u32 s51, s56, 409600
    s_add_u32 m0, s64, 5120
    s_nop 0
    buffer_load_dwordx4 v4, s[36:39], s51 offen lds
    buffer_load_dwordx4 v4, s[36:39], s51 offen offset:1024 lds
    buffer_load_dwordx4 v4, s[36:39], s51 offen offset:2048 lds
    buffer_load_dwordx4 v4, s[36:39], s51 offen offset:3072 lds
    s_add_u32 m0, s64, 9216
    s_nop 0
    buffer_load_dwordx4 v5, s[36:39], s51 offen lds
    s_add_u32 s51, s56, 450560
    s_add_u32 m0, s64, 10240
    s_nop 0
    buffer_load_dwordx4 v4, s[36:39], s51 offen lds
    buffer_load_dwordx4 v4, s[36:39], s51 offen offset:1024 lds
    buffer_load_dwordx4 v4, s[36:39], s51 offen offset:2048 lds
    buffer_load_dwordx4 v4, s[36:39], s51 offen offset:3072 lds
    s_add_u32 m0, s64, 14336
    s_nop 0
    buffer_load_dwordx4 v5, s[36:39], s51 offen lds
    s_add_u32 s24, s16, 11534336
    s_addc_u32 s25, s17, 0
    s_mov_b32 s26, 6291456
    s_mov_b32 s27, 0x20000
    s_mov_b64 exec, 1
    s_mov_b32 s68, 0x100000
g2_poll:
    s_sub_u32 s68, s68, 1
    s_cbranch_scc1 g2_ready
    buffer_load_dwordx4 v[164:167], v11, s[32:35], s46 offen sc1
    s_waitcnt vmcnt(0)
    v_and_b32 v164, v164, v165
    v_and_b32 v166, v166, v167
    v_and_b32 v164, v164, v166
    v_cmp_ne_u32 vcc, 1, v164
    s_nop 0
    s_cbranch_vccnz g2_poll
g2_ready:
    s_waitcnt vmcnt(0)
    s_mov_b64 exec, -1
    buffer_load_dwordx4 v[116:119], v6, s[24:27], s50 offen sc1
    buffer_load_dwordx4 v[120:123], v7, s[24:27], s50 offen sc1
    buffer_load_dwordx4 v[124:127], v8, s[24:27], s50 offen sc1
    buffer_load_dwordx4 v[128:131], v9, s[24:27], s50 offen sc1
    s_add_u32 s50, s50, 1024
    buffer_load_dwordx4 v[132:135], v6, s[24:27], s50 offen sc1
    buffer_load_dwordx4 v[136:139], v7, s[24:27], s50 offen sc1
    buffer_load_dwordx4 v[140:143], v8, s[24:27], s50 offen sc1
    buffer_load_dwordx4 v[144:147], v9, s[24:27], s50 offen sc1
    s_add_u32 s50, s50, 1024
    buffer_load_dwordx4 v[148:151], v6, s[24:27], s50 offen sc1
    buffer_load_dwordx4 v[152:155], v7, s[24:27], s50 offen sc1
    buffer_load_dwordx4 v[156:159], v8, s[24:27], s50 offen sc1
    buffer_load_dwordx4 v[160:163], v9, s[24:27], s50 offen sc1
    s_add_u32 s50, s50, 1024
    s_waitcnt vmcnt(11)
    v_mfma_f32_16x16x32_bf16 v[176:179], v[16:19], v[116:119], 0
    s_waitcnt vmcnt(10)
    v_mfma_f32_16x16x32_bf16 v[196:199], v[16:19], v[120:123], 0
    s_waitcnt vmcnt(9)
    v_mfma_f32_16x16x32_bf16 v[216:219], v[16:19], v[124:127], 0
    s_waitcnt vmcnt(8)
    v_mfma_f32_16x16x32_bf16 v[236:239], v[16:19], v[128:131], 0
    v_mfma_f32_16x16x32_bf16 v[180:183], v[20:23], v[116:119], 0
    v_mfma_f32_16x16x32_bf16 v[200:203], v[20:23], v[120:123], 0
    v_mfma_f32_16x16x32_bf16 v[220:223], v[20:23], v[124:127], 0
    v_mfma_f32_16x16x32_bf16 v[240:243], v[20:23], v[128:131], 0
    ds_read_b128 v[16:19], v13 offset:0
    v_mfma_f32_16x16x32_bf16 v[184:187], v[24:27], v[116:119], 0
    v_mfma_f32_16x16x32_bf16 v[204:207], v[24:27], v[120:123], 0
    v_mfma_f32_16x16x32_bf16 v[224:227], v[24:27], v[124:127], 0
    v_mfma_f32_16x16x32_bf16 v[244:247], v[24:27], v[128:131], 0
    ds_read_b128 v[20:23], v13 offset:1024
    v_mfma_f32_16x16x32_bf16 v[188:191], v[28:31], v[116:119], 0
    v_mfma_f32_16x16x32_bf16 v[208:211], v[28:31], v[120:123], 0
    v_mfma_f32_16x16x32_bf16 v[228:231], v[28:31], v[124:127], 0
    v_mfma_f32_16x16x32_bf16 v[248:251], v[28:31], v[128:131], 0
    ds_read_b128 v[24:27], v13 offset:2048
    v_mfma_f32_16x16x32_bf16 v[192:195], v[32:35], v[116:119], 0
    v_mfma_f32_16x16x32_bf16 v[212:215], v[32:35], v[120:123], 0
    v_mfma_f32_16x16x32_bf16 v[232:235], v[32:35], v[124:127], 0
    v_mfma_f32_16x16x32_bf16 v[252:255], v[32:35], v[128:131], 0
    ds_read_b128 v[28:31], v13 offset:3072
    buffer_load_dwordx4 v[116:119], v6, s[24:27], s50 offen sc1
    buffer_load_dwordx4 v[120:123], v7, s[24:27], s50 offen sc1
    buffer_load_dwordx4 v[124:127], v8, s[24:27], s50 offen sc1
    buffer_load_dwordx4 v[128:131], v9, s[24:27], s50 offen sc1
    s_add_u32 s50, s50, 1024
    ds_read_b128 v[32:35], v13 offset:4096
    s_waitcnt vmcnt(11)
    v_mfma_f32_16x16x32_bf16 v[176:179], v[36:39], v[132:135], v[176:179]
    s_waitcnt vmcnt(10)
    v_mfma_f32_16x16x32_bf16 v[196:199], v[36:39], v[136:139], v[196:199]
    s_waitcnt vmcnt(9)
    v_mfma_f32_16x16x32_bf16 v[216:219], v[36:39], v[140:143], v[216:219]
    s_waitcnt vmcnt(8)
    v_mfma_f32_16x16x32_bf16 v[236:239], v[36:39], v[144:147], v[236:239]
    v_mfma_f32_16x16x32_bf16 v[180:183], v[40:43], v[132:135], v[180:183]
    v_mfma_f32_16x16x32_bf16 v[200:203], v[40:43], v[136:139], v[200:203]
    v_mfma_f32_16x16x32_bf16 v[220:223], v[40:43], v[140:143], v[220:223]
    v_mfma_f32_16x16x32_bf16 v[240:243], v[40:43], v[144:147], v[240:243]
    ds_read_b128 v[36:39], v13 offset:20480
    v_mfma_f32_16x16x32_bf16 v[184:187], v[44:47], v[132:135], v[184:187]
    v_mfma_f32_16x16x32_bf16 v[204:207], v[44:47], v[136:139], v[204:207]
    v_mfma_f32_16x16x32_bf16 v[224:227], v[44:47], v[140:143], v[224:227]
    v_mfma_f32_16x16x32_bf16 v[244:247], v[44:47], v[144:147], v[244:247]
    ds_read_b128 v[40:43], v13 offset:21504
    v_mfma_f32_16x16x32_bf16 v[188:191], v[48:51], v[132:135], v[188:191]
    v_mfma_f32_16x16x32_bf16 v[208:211], v[48:51], v[136:139], v[208:211]
    v_mfma_f32_16x16x32_bf16 v[228:231], v[48:51], v[140:143], v[228:231]
    v_mfma_f32_16x16x32_bf16 v[248:251], v[48:51], v[144:147], v[248:251]
    ds_read_b128 v[44:47], v13 offset:22528
    v_mfma_f32_16x16x32_bf16 v[192:195], v[52:55], v[132:135], v[192:195]
    v_mfma_f32_16x16x32_bf16 v[212:215], v[52:55], v[136:139], v[212:215]
    v_mfma_f32_16x16x32_bf16 v[232:235], v[52:55], v[140:143], v[232:235]
    v_mfma_f32_16x16x32_bf16 v[252:255], v[52:55], v[144:147], v[252:255]
    ds_read_b128 v[48:51], v13 offset:23552
    buffer_load_dwordx4 v[132:135], v6, s[24:27], s50 offen sc1
    buffer_load_dwordx4 v[136:139], v7, s[24:27], s50 offen sc1
    buffer_load_dwordx4 v[140:143], v8, s[24:27], s50 offen sc1
    buffer_load_dwordx4 v[144:147], v9, s[24:27], s50 offen sc1
    s_add_u32 s50, s50, 1024
    ds_read_b128 v[52:55], v13 offset:24576
    s_waitcnt vmcnt(11)
    v_mfma_f32_16x16x32_bf16 v[176:179], v[56:59], v[148:151], v[176:179]
    s_waitcnt vmcnt(10)
    v_mfma_f32_16x16x32_bf16 v[196:199], v[56:59], v[152:155], v[196:199]
    s_waitcnt vmcnt(9)
    v_mfma_f32_16x16x32_bf16 v[216:219], v[56:59], v[156:159], v[216:219]
    s_waitcnt vmcnt(8)
    v_mfma_f32_16x16x32_bf16 v[236:239], v[56:59], v[160:163], v[236:239]
    v_mfma_f32_16x16x32_bf16 v[180:183], v[60:63], v[148:151], v[180:183]
    v_mfma_f32_16x16x32_bf16 v[200:203], v[60:63], v[152:155], v[200:203]
    v_mfma_f32_16x16x32_bf16 v[220:223], v[60:63], v[156:159], v[220:223]
    v_mfma_f32_16x16x32_bf16 v[240:243], v[60:63], v[160:163], v[240:243]
    ds_read_b128 v[56:59], v13 offset:40960
    v_mfma_f32_16x16x32_bf16 v[184:187], v[64:67], v[148:151], v[184:187]
    v_mfma_f32_16x16x32_bf16 v[204:207], v[64:67], v[152:155], v[204:207]
    v_mfma_f32_16x16x32_bf16 v[224:227], v[64:67], v[156:159], v[224:227]
    v_mfma_f32_16x16x32_bf16 v[244:247], v[64:67], v[160:163], v[244:247]
    ds_read_b128 v[60:63], v13 offset:41984
    v_mfma_f32_16x16x32_bf16 v[188:191], v[68:71], v[148:151], v[188:191]
    v_mfma_f32_16x16x32_bf16 v[208:211], v[68:71], v[152:155], v[208:211]
    v_mfma_f32_16x16x32_bf16 v[228:231], v[68:71], v[156:159], v[228:231]
    v_mfma_f32_16x16x32_bf16 v[248:251], v[68:71], v[160:163], v[248:251]
    ds_read_b128 v[64:67], v13 offset:43008
    v_mfma_f32_16x16x32_bf16 v[192:195], v[72:75], v[148:151], v[192:195]
    v_mfma_f32_16x16x32_bf16 v[212:215], v[72:75], v[152:155], v[212:215]
    v_mfma_f32_16x16x32_bf16 v[232:235], v[72:75], v[156:159], v[232:235]
    v_mfma_f32_16x16x32_bf16 v[252:255], v[72:75], v[160:163], v[252:255]
    ds_read_b128 v[68:71], v13 offset:44032
    buffer_load_dwordx4 v[148:151], v6, s[24:27], s50 offen sc1
    buffer_load_dwordx4 v[152:155], v7, s[24:27], s50 offen sc1
    buffer_load_dwordx4 v[156:159], v8, s[24:27], s50 offen sc1
    buffer_load_dwordx4 v[160:163], v9, s[24:27], s50 offen sc1
    s_add_u32 s50, s50, 1024
    ds_read_b128 v[72:75], v13 offset:45056
    s_waitcnt vmcnt(11)
    v_mfma_f32_16x16x32_bf16 v[176:179], v[76:79], v[116:119], v[176:179]
    s_waitcnt vmcnt(10)
    v_mfma_f32_16x16x32_bf16 v[196:199], v[76:79], v[120:123], v[196:199]
    s_waitcnt vmcnt(9)
    v_mfma_f32_16x16x32_bf16 v[216:219], v[76:79], v[124:127], v[216:219]
    s_waitcnt vmcnt(8)
    v_mfma_f32_16x16x32_bf16 v[236:239], v[76:79], v[128:131], v[236:239]
    v_mfma_f32_16x16x32_bf16 v[180:183], v[80:83], v[116:119], v[180:183]
    v_mfma_f32_16x16x32_bf16 v[200:203], v[80:83], v[120:123], v[200:203]
    v_mfma_f32_16x16x32_bf16 v[220:223], v[80:83], v[124:127], v[220:223]
    v_mfma_f32_16x16x32_bf16 v[240:243], v[80:83], v[128:131], v[240:243]
    ds_read_b128 v[76:79], v15 offset:0
    v_mfma_f32_16x16x32_bf16 v[184:187], v[84:87], v[116:119], v[184:187]
    v_mfma_f32_16x16x32_bf16 v[204:207], v[84:87], v[120:123], v[204:207]
    v_mfma_f32_16x16x32_bf16 v[224:227], v[84:87], v[124:127], v[224:227]
    v_mfma_f32_16x16x32_bf16 v[244:247], v[84:87], v[128:131], v[244:247]
    ds_read_b128 v[80:83], v15 offset:1024
    v_mfma_f32_16x16x32_bf16 v[188:191], v[88:91], v[116:119], v[188:191]
    v_mfma_f32_16x16x32_bf16 v[208:211], v[88:91], v[120:123], v[208:211]
    v_mfma_f32_16x16x32_bf16 v[228:231], v[88:91], v[124:127], v[228:231]
    v_mfma_f32_16x16x32_bf16 v[248:251], v[88:91], v[128:131], v[248:251]
    ds_read_b128 v[84:87], v15 offset:2048
    v_mfma_f32_16x16x32_bf16 v[192:195], v[92:95], v[116:119], v[192:195]
    v_mfma_f32_16x16x32_bf16 v[212:215], v[92:95], v[120:123], v[212:215]
    v_mfma_f32_16x16x32_bf16 v[232:235], v[92:95], v[124:127], v[232:235]
    v_mfma_f32_16x16x32_bf16 v[252:255], v[92:95], v[128:131], v[252:255]
    ds_read_b128 v[88:91], v15 offset:3072
    buffer_load_dwordx4 v[116:119], v6, s[24:27], s50 offen sc1
    buffer_load_dwordx4 v[120:123], v7, s[24:27], s50 offen sc1
    buffer_load_dwordx4 v[124:127], v8, s[24:27], s50 offen sc1
    buffer_load_dwordx4 v[128:131], v9, s[24:27], s50 offen sc1
    s_add_u32 s50, s50, 1024
    ds_read_b128 v[92:95], v15 offset:4096
    s_waitcnt vmcnt(11)
    v_mfma_f32_16x16x32_bf16 v[176:179], v[96:99], v[132:135], v[176:179]
    s_waitcnt vmcnt(10)
    v_mfma_f32_16x16x32_bf16 v[196:199], v[96:99], v[136:139], v[196:199]
    s_waitcnt vmcnt(9)
    v_mfma_f32_16x16x32_bf16 v[216:219], v[96:99], v[140:143], v[216:219]
    s_waitcnt vmcnt(8)
    v_mfma_f32_16x16x32_bf16 v[236:239], v[96:99], v[144:147], v[236:239]
    v_mfma_f32_16x16x32_bf16 v[180:183], v[100:103], v[132:135], v[180:183]
    v_mfma_f32_16x16x32_bf16 v[200:203], v[100:103], v[136:139], v[200:203]
    v_mfma_f32_16x16x32_bf16 v[220:223], v[100:103], v[140:143], v[220:223]
    v_mfma_f32_16x16x32_bf16 v[240:243], v[100:103], v[144:147], v[240:243]
    ds_read_b128 v[96:99], v14 offset:0
    v_mfma_f32_16x16x32_bf16 v[184:187], v[104:107], v[132:135], v[184:187]
    v_mfma_f32_16x16x32_bf16 v[204:207], v[104:107], v[136:139], v[204:207]
    v_mfma_f32_16x16x32_bf16 v[224:227], v[104:107], v[140:143], v[224:227]
    v_mfma_f32_16x16x32_bf16 v[244:247], v[104:107], v[144:147], v[244:247]
    ds_read_b128 v[100:103], v14 offset:1024
    v_mfma_f32_16x16x32_bf16 v[188:191], v[108:111], v[132:135], v[188:191]
    v_mfma_f32_16x16x32_bf16 v[208:211], v[108:111], v[136:139], v[208:211]
    v_mfma_f32_16x16x32_bf16 v[228:231], v[108:111], v[140:143], v[228:231]
    v_mfma_f32_16x16x32_bf16 v[248:251], v[108:111], v[144:147], v[248:251]
    ds_read_b128 v[104:107], v14 offset:2048
    v_mfma_f32_16x16x32_bf16 v[192:195], v[112:115], v[132:135], v[192:195]
    v_mfma_f32_16x16x32_bf16 v[212:215], v[112:115], v[136:139], v[212:215]
    v_mfma_f32_16x16x32_bf16 v[232:235], v[112:115], v[140:143], v[232:235]
    v_mfma_f32_16x16x32_bf16 v[252:255], v[112:115], v[144:147], v[252:255]
    ds_read_b128 v[108:111], v14 offset:3072
    buffer_load_dwordx4 v[132:135], v6, s[24:27], s50 offen sc1
    buffer_load_dwordx4 v[136:139], v7, s[24:27], s50 offen sc1
    buffer_load_dwordx4 v[140:143], v8, s[24:27], s50 offen sc1
    buffer_load_dwordx4 v[144:147], v9, s[24:27], s50 offen sc1
    s_add_u32 s50, s50, 1024
    ds_read_b128 v[112:115], v14 offset:4096
    s_waitcnt vmcnt(11) lgkmcnt(15)
    v_mfma_f32_16x16x32_bf16 v[176:179], v[16:19], v[148:151], v[176:179]
    s_waitcnt vmcnt(10)
    v_mfma_f32_16x16x32_bf16 v[196:199], v[16:19], v[152:155], v[196:199]
    s_waitcnt vmcnt(9)
    v_mfma_f32_16x16x32_bf16 v[216:219], v[16:19], v[156:159], v[216:219]
    s_waitcnt vmcnt(8)
    v_mfma_f32_16x16x32_bf16 v[236:239], v[16:19], v[160:163], v[236:239]
    v_mfma_f32_16x16x32_bf16 v[180:183], v[20:23], v[148:151], v[180:183]
    v_mfma_f32_16x16x32_bf16 v[200:203], v[20:23], v[152:155], v[200:203]
    v_mfma_f32_16x16x32_bf16 v[220:223], v[20:23], v[156:159], v[220:223]
    v_mfma_f32_16x16x32_bf16 v[240:243], v[20:23], v[160:163], v[240:243]
    ds_read_b128 v[16:19], v14 offset:5120
    v_mfma_f32_16x16x32_bf16 v[184:187], v[24:27], v[148:151], v[184:187]
    v_mfma_f32_16x16x32_bf16 v[204:207], v[24:27], v[152:155], v[204:207]
    v_mfma_f32_16x16x32_bf16 v[224:227], v[24:27], v[156:159], v[224:227]
    v_mfma_f32_16x16x32_bf16 v[244:247], v[24:27], v[160:163], v[244:247]
    ds_read_b128 v[20:23], v14 offset:6144
    v_mfma_f32_16x16x32_bf16 v[188:191], v[28:31], v[148:151], v[188:191]
    v_mfma_f32_16x16x32_bf16 v[208:211], v[28:31], v[152:155], v[208:211]
    v_mfma_f32_16x16x32_bf16 v[228:231], v[28:31], v[156:159], v[228:231]
    v_mfma_f32_16x16x32_bf16 v[248:251], v[28:31], v[160:163], v[248:251]
    ds_read_b128 v[24:27], v14 offset:7168
    v_mfma_f32_16x16x32_bf16 v[192:195], v[32:35], v[148:151], v[192:195]
    v_mfma_f32_16x16x32_bf16 v[212:215], v[32:35], v[152:155], v[212:215]
    v_mfma_f32_16x16x32_bf16 v[232:235], v[32:35], v[156:159], v[232:235]
    v_mfma_f32_16x16x32_bf16 v[252:255], v[32:35], v[160:163], v[252:255]
    ds_read_b128 v[28:31], v14 offset:8192
    buffer_load_dwordx4 v[148:151], v6, s[24:27], s50 offen sc1
    buffer_load_dwordx4 v[152:155], v7, s[24:27], s50 offen sc1
    buffer_load_dwordx4 v[156:159], v8, s[24:27], s50 offen sc1
    buffer_load_dwordx4 v[160:163], v9, s[24:27], s50 offen sc1
    s_add_u32 s50, s50, 1024
    ds_read_b128 v[32:35], v14 offset:9216
    s_waitcnt vmcnt(11)
    v_mfma_f32_16x16x32_bf16 v[176:179], v[36:39], v[116:119], v[176:179]
    s_waitcnt vmcnt(10)
    v_mfma_f32_16x16x32_bf16 v[196:199], v[36:39], v[120:123], v[196:199]
    s_waitcnt vmcnt(9)
    v_mfma_f32_16x16x32_bf16 v[216:219], v[36:39], v[124:127], v[216:219]
    s_waitcnt vmcnt(8)
    v_mfma_f32_16x16x32_bf16 v[236:239], v[36:39], v[128:131], v[236:239]
    v_mfma_f32_16x16x32_bf16 v[180:183], v[40:43], v[116:119], v[180:183]
    v_mfma_f32_16x16x32_bf16 v[200:203], v[40:43], v[120:123], v[200:203]
    v_mfma_f32_16x16x32_bf16 v[220:223], v[40:43], v[124:127], v[220:223]
    v_mfma_f32_16x16x32_bf16 v[240:243], v[40:43], v[128:131], v[240:243]
    ds_read_b128 v[36:39], v14 offset:10240
    v_mfma_f32_16x16x32_bf16 v[184:187], v[44:47], v[116:119], v[184:187]
    v_mfma_f32_16x16x32_bf16 v[204:207], v[44:47], v[120:123], v[204:207]
    v_mfma_f32_16x16x32_bf16 v[224:227], v[44:47], v[124:127], v[224:227]
    v_mfma_f32_16x16x32_bf16 v[244:247], v[44:47], v[128:131], v[244:247]
    ds_read_b128 v[40:43], v14 offset:11264
    v_mfma_f32_16x16x32_bf16 v[188:191], v[48:51], v[116:119], v[188:191]
    v_mfma_f32_16x16x32_bf16 v[208:211], v[48:51], v[120:123], v[208:211]
    v_mfma_f32_16x16x32_bf16 v[228:231], v[48:51], v[124:127], v[228:231]
    v_mfma_f32_16x16x32_bf16 v[248:251], v[48:51], v[128:131], v[248:251]
    ds_read_b128 v[44:47], v14 offset:12288
    v_mfma_f32_16x16x32_bf16 v[192:195], v[52:55], v[116:119], v[192:195]
    v_mfma_f32_16x16x32_bf16 v[212:215], v[52:55], v[120:123], v[212:215]
    v_mfma_f32_16x16x32_bf16 v[232:235], v[52:55], v[124:127], v[232:235]
    v_mfma_f32_16x16x32_bf16 v[252:255], v[52:55], v[128:131], v[252:255]
    ds_read_b128 v[48:51], v14 offset:13312
    buffer_load_dwordx4 v[116:119], v6, s[24:27], s50 offen sc1
    buffer_load_dwordx4 v[120:123], v7, s[24:27], s50 offen sc1
    buffer_load_dwordx4 v[124:127], v8, s[24:27], s50 offen sc1
    buffer_load_dwordx4 v[128:131], v9, s[24:27], s50 offen sc1
    s_add_u32 s50, s50, 1024
    ds_read_b128 v[52:55], v14 offset:14336
    s_waitcnt vmcnt(11) lgkmcnt(15)
    v_mfma_f32_16x16x32_bf16 v[176:179], v[56:59], v[132:135], v[176:179]
    s_waitcnt vmcnt(10)
    v_mfma_f32_16x16x32_bf16 v[196:199], v[56:59], v[136:139], v[196:199]
    s_waitcnt vmcnt(9)
    v_mfma_f32_16x16x32_bf16 v[216:219], v[56:59], v[140:143], v[216:219]
    s_waitcnt vmcnt(8)
    v_mfma_f32_16x16x32_bf16 v[236:239], v[56:59], v[144:147], v[236:239]
    v_mfma_f32_16x16x32_bf16 v[180:183], v[60:63], v[132:135], v[180:183]
    v_mfma_f32_16x16x32_bf16 v[200:203], v[60:63], v[136:139], v[200:203]
    v_mfma_f32_16x16x32_bf16 v[220:223], v[60:63], v[140:143], v[220:223]
    v_mfma_f32_16x16x32_bf16 v[240:243], v[60:63], v[144:147], v[240:243]
    v_mfma_f32_16x16x32_bf16 v[184:187], v[64:67], v[132:135], v[184:187]
    v_mfma_f32_16x16x32_bf16 v[204:207], v[64:67], v[136:139], v[204:207]
    v_mfma_f32_16x16x32_bf16 v[224:227], v[64:67], v[140:143], v[224:227]
    v_mfma_f32_16x16x32_bf16 v[244:247], v[64:67], v[144:147], v[244:247]
    v_mfma_f32_16x16x32_bf16 v[188:191], v[68:71], v[132:135], v[188:191]
    v_mfma_f32_16x16x32_bf16 v[208:211], v[68:71], v[136:139], v[208:211]
    v_mfma_f32_16x16x32_bf16 v[228:231], v[68:71], v[140:143], v[228:231]
    v_mfma_f32_16x16x32_bf16 v[248:251], v[68:71], v[144:147], v[248:251]
    v_mfma_f32_16x16x32_bf16 v[192:195], v[72:75], v[132:135], v[192:195]
    v_mfma_f32_16x16x32_bf16 v[212:215], v[72:75], v[136:139], v[212:215]
    v_mfma_f32_16x16x32_bf16 v[232:235], v[72:75], v[140:143], v[232:235]
    v_mfma_f32_16x16x32_bf16 v[252:255], v[72:75], v[144:147], v[252:255]
    buffer_load_dwordx4 v[132:135], v6, s[24:27], s50 offen sc1
    buffer_load_dwordx4 v[136:139], v7, s[24:27], s50 offen sc1
    buffer_load_dwordx4 v[140:143], v8, s[24:27], s50 offen sc1
    buffer_load_dwordx4 v[144:147], v9, s[24:27], s50 offen sc1
    s_add_u32 s50, s50, 1024
    s_waitcnt vmcnt(11)
    v_mfma_f32_16x16x32_bf16 v[176:179], v[76:79], v[148:151], v[176:179]
    s_waitcnt vmcnt(10)
    v_mfma_f32_16x16x32_bf16 v[196:199], v[76:79], v[152:155], v[196:199]
    s_waitcnt vmcnt(9)
    v_mfma_f32_16x16x32_bf16 v[216:219], v[76:79], v[156:159], v[216:219]
    s_waitcnt vmcnt(8)
    v_mfma_f32_16x16x32_bf16 v[236:239], v[76:79], v[160:163], v[236:239]
    v_mfma_f32_16x16x32_bf16 v[180:183], v[80:83], v[148:151], v[180:183]
    v_mfma_f32_16x16x32_bf16 v[200:203], v[80:83], v[152:155], v[200:203]
    v_mfma_f32_16x16x32_bf16 v[220:223], v[80:83], v[156:159], v[220:223]
    v_mfma_f32_16x16x32_bf16 v[240:243], v[80:83], v[160:163], v[240:243]
    v_mfma_f32_16x16x32_bf16 v[184:187], v[84:87], v[148:151], v[184:187]
    v_mfma_f32_16x16x32_bf16 v[204:207], v[84:87], v[152:155], v[204:207]
    v_mfma_f32_16x16x32_bf16 v[224:227], v[84:87], v[156:159], v[224:227]
    v_mfma_f32_16x16x32_bf16 v[244:247], v[84:87], v[160:163], v[244:247]
    v_mfma_f32_16x16x32_bf16 v[188:191], v[88:91], v[148:151], v[188:191]
    v_mfma_f32_16x16x32_bf16 v[208:211], v[88:91], v[152:155], v[208:211]
    v_mfma_f32_16x16x32_bf16 v[228:231], v[88:91], v[156:159], v[228:231]
    v_mfma_f32_16x16x32_bf16 v[248:251], v[88:91], v[160:163], v[248:251]
    v_mfma_f32_16x16x32_bf16 v[192:195], v[92:95], v[148:151], v[192:195]
    v_mfma_f32_16x16x32_bf16 v[212:215], v[92:95], v[152:155], v[212:215]
    v_mfma_f32_16x16x32_bf16 v[232:235], v[92:95], v[156:159], v[232:235]
    v_mfma_f32_16x16x32_bf16 v[252:255], v[92:95], v[160:163], v[252:255]
    buffer_load_dwordx4 v[148:151], v6, s[24:27], s50 offen sc1
    buffer_load_dwordx4 v[152:155], v7, s[24:27], s50 offen sc1
    buffer_load_dwordx4 v[156:159], v8, s[24:27], s50 offen sc1
    buffer_load_dwordx4 v[160:163], v9, s[24:27], s50 offen sc1
    s_add_u32 s50, s50, 1024
    s_waitcnt vmcnt(11) lgkmcnt(14)
    v_mfma_f32_16x16x32_bf16 v[176:179], v[96:99], v[116:119], v[176:179]
    s_waitcnt vmcnt(10)
    v_mfma_f32_16x16x32_bf16 v[196:199], v[96:99], v[120:123], v[196:199]
    s_waitcnt vmcnt(9)
    v_mfma_f32_16x16x32_bf16 v[216:219], v[96:99], v[124:127], v[216:219]
    s_waitcnt vmcnt(8)
    v_mfma_f32_16x16x32_bf16 v[236:239], v[96:99], v[128:131], v[236:239]
    s_waitcnt lgkmcnt(13)
    v_mfma_f32_16x16x32_bf16 v[180:183], v[100:103], v[116:119], v[180:183]
    v_mfma_f32_16x16x32_bf16 v[200:203], v[100:103], v[120:123], v[200:203]
    v_mfma_f32_16x16x32_bf16 v[220:223], v[100:103], v[124:127], v[220:223]
    v_mfma_f32_16x16x32_bf16 v[240:243], v[100:103], v[128:131], v[240:243]
    s_waitcnt lgkmcnt(12)
    v_mfma_f32_16x16x32_bf16 v[184:187], v[104:107], v[116:119], v[184:187]
    v_mfma_f32_16x16x32_bf16 v[204:207], v[104:107], v[120:123], v[204:207]
    v_mfma_f32_16x16x32_bf16 v[224:227], v[104:107], v[124:127], v[224:227]
    v_mfma_f32_16x16x32_bf16 v[244:247], v[104:107], v[128:131], v[244:247]
    s_waitcnt lgkmcnt(11)
    v_mfma_f32_16x16x32_bf16 v[188:191], v[108:111], v[116:119], v[188:191]
    v_mfma_f32_16x16x32_bf16 v[208:211], v[108:111], v[120:123], v[208:211]
    v_mfma_f32_16x16x32_bf16 v[228:231], v[108:111], v[124:127], v[228:231]
    v_mfma_f32_16x16x32_bf16 v[248:251], v[108:111], v[128:131], v[248:251]
    s_waitcnt lgkmcnt(10)
    v_mfma_f32_16x16x32_bf16 v[192:195], v[112:115], v[116:119], v[192:195]
    v_mfma_f32_16x16x32_bf16 v[212:215], v[112:115], v[120:123], v[212:215]
    v_mfma_f32_16x16x32_bf16 v[232:235], v[112:115], v[124:127], v[232:235]
    v_mfma_f32_16x16x32_bf16 v[252:255], v[112:115], v[128:131], v[252:255]
    s_waitcnt vmcnt(7) lgkmcnt(9)
    v_mfma_f32_16x16x32_bf16 v[176:179], v[16:19], v[132:135], v[176:179]
    s_waitcnt vmcnt(6)
    v_mfma_f32_16x16x32_bf16 v[196:199], v[16:19], v[136:139], v[196:199]
    s_waitcnt vmcnt(5)
    v_mfma_f32_16x16x32_bf16 v[216:219], v[16:19], v[140:143], v[216:219]
    s_waitcnt vmcnt(4)
    v_mfma_f32_16x16x32_bf16 v[236:239], v[16:19], v[144:147], v[236:239]
    s_waitcnt lgkmcnt(8)
    v_mfma_f32_16x16x32_bf16 v[180:183], v[20:23], v[132:135], v[180:183]
    v_mfma_f32_16x16x32_bf16 v[200:203], v[20:23], v[136:139], v[200:203]
    v_mfma_f32_16x16x32_bf16 v[220:223], v[20:23], v[140:143], v[220:223]
    v_mfma_f32_16x16x32_bf16 v[240:243], v[20:23], v[144:147], v[240:243]
    s_waitcnt lgkmcnt(7)
    v_mfma_f32_16x16x32_bf16 v[184:187], v[24:27], v[132:135], v[184:187]
    v_mfma_f32_16x16x32_bf16 v[204:207], v[24:27], v[136:139], v[204:207]
    v_mfma_f32_16x16x32_bf16 v[224:227], v[24:27], v[140:143], v[224:227]
    v_mfma_f32_16x16x32_bf16 v[244:247], v[24:27], v[144:147], v[244:247]
    s_waitcnt lgkmcnt(6)
    v_mfma_f32_16x16x32_bf16 v[188:191], v[28:31], v[132:135], v[188:191]
    v_mfma_f32_16x16x32_bf16 v[208:211], v[28:31], v[136:139], v[208:211]
    v_mfma_f32_16x16x32_bf16 v[228:231], v[28:31], v[140:143], v[228:231]
    v_mfma_f32_16x16x32_bf16 v[248:251], v[28:31], v[144:147], v[248:251]
    s_waitcnt lgkmcnt(5)
    v_mfma_f32_16x16x32_bf16 v[192:195], v[32:35], v[132:135], v[192:195]
    v_mfma_f32_16x16x32_bf16 v[212:215], v[32:35], v[136:139], v[212:215]
    v_mfma_f32_16x16x32_bf16 v[232:235], v[32:35], v[140:143], v[232:235]
    v_mfma_f32_16x16x32_bf16 v[252:255], v[32:35], v[144:147], v[252:255]
    s_waitcnt vmcnt(3) lgkmcnt(4)
    v_mfma_f32_16x16x32_bf16 v[176:179], v[36:39], v[148:151], v[176:179]
    s_waitcnt vmcnt(2)
    v_mfma_f32_16x16x32_bf16 v[196:199], v[36:39], v[152:155], v[196:199]
    s_waitcnt vmcnt(1)
    v_mfma_f32_16x16x32_bf16 v[216:219], v[36:39], v[156:159], v[216:219]
    s_waitcnt vmcnt(0)
    v_mfma_f32_16x16x32_bf16 v[236:239], v[36:39], v[160:163], v[236:239]
    s_waitcnt lgkmcnt(3)
    v_mfma_f32_16x16x32_bf16 v[180:183], v[40:43], v[148:151], v[180:183]
    v_mfma_f32_16x16x32_bf16 v[200:203], v[40:43], v[152:155], v[200:203]
    v_mfma_f32_16x16x32_bf16 v[220:223], v[40:43], v[156:159], v[220:223]
    v_mfma_f32_16x16x32_bf16 v[240:243], v[40:43], v[160:163], v[240:243]
    s_waitcnt lgkmcnt(2)
    v_mfma_f32_16x16x32_bf16 v[184:187], v[44:47], v[148:151], v[184:187]
    v_mfma_f32_16x16x32_bf16 v[204:207], v[44:47], v[152:155], v[204:207]
    v_mfma_f32_16x16x32_bf16 v[224:227], v[44:47], v[156:159], v[224:227]
    v_mfma_f32_16x16x32_bf16 v[244:247], v[44:47], v[160:163], v[244:247]
    s_waitcnt lgkmcnt(1)
    v_mfma_f32_16x16x32_bf16 v[188:191], v[48:51], v[148:151], v[188:191]
    v_mfma_f32_16x16x32_bf16 v[208:211], v[48:51], v[152:155], v[208:211]
    v_mfma_f32_16x16x32_bf16 v[228:231], v[48:51], v[156:159], v[228:231]
    v_mfma_f32_16x16x32_bf16 v[248:251], v[48:51], v[160:163], v[248:251]
    s_waitcnt lgkmcnt(0)
    v_mfma_f32_16x16x32_bf16 v[192:195], v[52:55], v[148:151], v[192:195]
    v_mfma_f32_16x16x32_bf16 v[212:215], v[52:55], v[152:155], v[212:215]
    v_mfma_f32_16x16x32_bf16 v[232:235], v[52:55], v[156:159], v[232:235]
    v_mfma_f32_16x16x32_bf16 v[252:255], v[52:55], v[160:163], v[252:255]
    s_barrier
    s_add_u32 s49, s41, 1
    s_and_b32 s49, s49, 3
    s_mul_i32 s49, s49, 15360
    v_add_u32 v12, s49, v4
    s_add_u32 s49, s41, 2
    s_and_b32 s49, s49, 3
    s_mul_i32 s49, s49, 15360
    v_add_u32 v13, s49, v4
    s_add_u32 s49, s41, 3
    s_and_b32 s49, s49, 3
    s_mul_i32 s49, s49, 15360
    v_add_u32 v14, s49, v4
    ds_write_b128 v12, v[196:199] offset:0
    ds_write_b128 v12, v[200:203] offset:1024
    ds_write_b128 v12, v[204:207] offset:2048
    ds_write_b128 v12, v[208:211] offset:3072
    ds_write_b128 v12, v[212:215] offset:4096
    ds_write_b128 v13, v[216:219] offset:5120
    ds_write_b128 v13, v[220:223] offset:6144
    ds_write_b128 v13, v[224:227] offset:7168
    ds_write_b128 v13, v[228:231] offset:8192
    ds_write_b128 v13, v[232:235] offset:9216
    ds_write_b128 v14, v[236:239] offset:10240
    ds_write_b128 v14, v[240:243] offset:11264
    ds_write_b128 v14, v[244:247] offset:12288
    ds_write_b128 v14, v[248:251] offset:13312
    ds_write_b128 v14, v[252:255] offset:14336
    s_mul_i32 s49, s41, 15360
    v_add_u32 v8, s49, v4
    v_lshrrev_b32 v1, 4, v0
    v_bfe_u32 v2, v0, 2, 2
    v_bfe_u32 v3, v0, 4, 1
    v_lshl_add_u32 v2, v3, 2, v2
    v_and_b32 v3, 3, v0
    v_bfe_u32 v2, v0, 2, 2
    v_lshl_add_u32 v2, v1, 2, v2
    v_lshlrev_b32 v2, 7, v2
    v_lshl_add_u32 v2, v3, 3, v2
    s_lshl_b32 s49, s41, 5
    s_add_u32 s49, s49, 61440
    v_add_u32 v2, s49, v2
    v_and_b32 v9, 15, v0
    v_mul_u32_u24 v9, 1280, v9
    v_lshlrev_b32 v10, 3, v1
    v_add_u32 v11, v9, v10
    v_and_b32 v10, 1, v1
    v_lshl_add_u32 v9, v10, 5, v9
    v_lshrrev_b32 v10, 1, v1
    v_lshl_add_u32 v9, v10, 4, v9
    s_lshl_b32 s43, s22, 2
    s_add_u32 s43, s43, s41
    s_mul_i32 s43, s43, 20480
    s_mul_i32 s44, s47, 160
    s_add_u32 s43, s43, s44
    s_mov_b32 s28, s10
    s_mov_b32 s29, s11
    s_mov_b32 s30, 2621440
    s_mov_b32 s31, 0x20000
    s_mov_b32 s51, 0x00003f80
    s_mov_b32 s52, 0x3f800000
    ds_read_b64_tr_b16 v[96:97], v2 offset:0
    ds_read_b64_tr_b16 v[98:99], v2 offset:2048
    ds_read_b64_tr_b16 v[100:101], v2 offset:4096
    ds_read_b64_tr_b16 v[102:103], v2 offset:6144
    ds_read_b64_tr_b16 v[104:105], v2 offset:8192
    s_waitcnt lgkmcnt(4)
    v_lshlrev_b32 v120, 16, v96
    v_and_b32 v121, 0xffff0000, v96
    v_lshlrev_b32 v122, 16, v97
    v_and_b32 v123, 0xffff0000, v97
    s_waitcnt lgkmcnt(3)
    v_lshlrev_b32 v124, 16, v98
    v_and_b32 v125, 0xffff0000, v98
    v_lshlrev_b32 v126, 16, v99
    v_and_b32 v127, 0xffff0000, v99
    s_waitcnt lgkmcnt(2)
    v_lshlrev_b32 v128, 16, v100
    v_and_b32 v129, 0xffff0000, v100
    v_lshlrev_b32 v130, 16, v101
    v_and_b32 v131, 0xffff0000, v101
    s_waitcnt lgkmcnt(1)
    v_lshlrev_b32 v132, 16, v102
    v_and_b32 v133, 0xffff0000, v102
    v_lshlrev_b32 v134, 16, v103
    v_and_b32 v135, 0xffff0000, v103
    s_waitcnt lgkmcnt(0)
    v_lshlrev_b32 v136, 16, v104
    v_and_b32 v137, 0xffff0000, v104
    v_lshlrev_b32 v138, 16, v105
    v_and_b32 v139, 0xffff0000, v105
    s_waitcnt lgkmcnt(0)
    s_barrier
    ds_read_b128 v[36:39], v8 offset:0
    ds_read_b128 v[40:43], v8 offset:1024
    ds_read_b128 v[44:47], v8 offset:2048
    ds_read_b128 v[48:51], v8 offset:3072
    ds_read_b128 v[52:55], v8 offset:4096
    ds_read_b128 v[56:59], v8 offset:5120
    ds_read_b128 v[60:63], v8 offset:6144
    ds_read_b128 v[64:67], v8 offset:7168
    ds_read_b128 v[68:71], v8 offset:8192
    ds_read_b128 v[72:75], v8 offset:9216
    ds_read_b128 v[76:79], v8 offset:10240
    ds_read_b128 v[80:83], v8 offset:11264
    ds_read_b128 v[84:87], v8 offset:12288
    ds_read_b128 v[88:91], v8 offset:13312
    ds_read_b128 v[92:95], v8 offset:14336
    s_waitcnt lgkmcnt(14)
    v_pk_add_f32 v[176:177], v[176:177], v[36:37]
    v_pk_add_f32 v[178:179], v[178:179], v[38:39]
    s_waitcnt lgkmcnt(13)
    v_pk_add_f32 v[180:181], v[180:181], v[40:41]
    v_pk_add_f32 v[182:183], v[182:183], v[42:43]
    s_waitcnt lgkmcnt(12)
    v_pk_add_f32 v[184:185], v[184:185], v[44:45]
    v_pk_add_f32 v[186:187], v[186:187], v[46:47]
    s_waitcnt lgkmcnt(11)
    v_pk_add_f32 v[188:189], v[188:189], v[48:49]
    v_pk_add_f32 v[190:191], v[190:191], v[50:51]
    s_waitcnt lgkmcnt(10)
    v_pk_add_f32 v[192:193], v[192:193], v[52:53]
    v_pk_add_f32 v[194:195], v[194:195], v[54:55]
    s_waitcnt lgkmcnt(9)
    v_pk_add_f32 v[176:177], v[176:177], v[56:57]
    v_pk_add_f32 v[178:179], v[178:179], v[58:59]
    s_waitcnt lgkmcnt(8)
    v_pk_add_f32 v[180:181], v[180:181], v[60:61]
    v_pk_add_f32 v[182:183], v[182:183], v[62:63]
    s_waitcnt lgkmcnt(7)
    v_pk_add_f32 v[184:185], v[184:185], v[64:65]
    v_pk_add_f32 v[186:187], v[186:187], v[66:67]
    s_waitcnt lgkmcnt(6)
    v_pk_add_f32 v[188:189], v[188:189], v[68:69]
    v_pk_add_f32 v[190:191], v[190:191], v[70:71]
    s_waitcnt lgkmcnt(5)
    v_pk_add_f32 v[192:193], v[192:193], v[72:73]
    v_pk_add_f32 v[194:195], v[194:195], v[74:75]
    s_waitcnt lgkmcnt(4)
    v_pk_add_f32 v[176:177], v[176:177], v[76:77]
    v_pk_add_f32 v[178:179], v[178:179], v[78:79]
    s_waitcnt lgkmcnt(3)
    v_pk_add_f32 v[180:181], v[180:181], v[80:81]
    v_pk_add_f32 v[182:183], v[182:183], v[82:83]
    s_waitcnt lgkmcnt(2)
    v_pk_add_f32 v[184:185], v[184:185], v[84:85]
    v_pk_add_f32 v[186:187], v[186:187], v[86:87]
    s_waitcnt lgkmcnt(1)
    v_pk_add_f32 v[188:189], v[188:189], v[88:89]
    v_pk_add_f32 v[190:191], v[190:191], v[90:91]
    s_waitcnt lgkmcnt(0)
    v_pk_add_f32 v[192:193], v[192:193], v[92:93]
    v_pk_add_f32 v[194:195], v[194:195], v[94:95]
    v_cvt_pk_bf16_f32 v108, v176, v177
    v_cvt_pk_bf16_f32 v109, v178, v179
    v_cvt_pk_bf16_f32 v110, v180, v181
    v_cvt_pk_bf16_f32 v111, v182, v183
    v_cvt_pk_bf16_f32 v112, v184, v185
    v_cvt_pk_bf16_f32 v113, v186, v187
    v_cvt_pk_bf16_f32 v114, v188, v189
    v_cvt_pk_bf16_f32 v115, v190, v191
    v_cvt_pk_bf16_f32 v116, v192, v193
    v_cvt_pk_bf16_f32 v117, v194, v195
    v_dot2_f32_bf16 v120, v108, s51, v120
    v_dot2_f32_bf16 v121, v108, s52, v121
    v_dot2_f32_bf16 v122, v109, s51, v122
    v_dot2_f32_bf16 v123, v109, s52, v123
    v_dot2_f32_bf16 v124, v110, s51, v124
    v_dot2_f32_bf16 v125, v110, s52, v125
    v_dot2_f32_bf16 v126, v111, s51, v126
    v_dot2_f32_bf16 v127, v111, s52, v127
    v_dot2_f32_bf16 v128, v112, s51, v128
    v_dot2_f32_bf16 v129, v112, s52, v129
    v_dot2_f32_bf16 v130, v113, s51, v130
    v_dot2_f32_bf16 v131, v113, s52, v131
    v_dot2_f32_bf16 v132, v114, s51, v132
    v_dot2_f32_bf16 v133, v114, s52, v133
    v_dot2_f32_bf16 v134, v115, s51, v134
    v_dot2_f32_bf16 v135, v115, s52, v135
    v_dot2_f32_bf16 v136, v116, s51, v136
    v_dot2_f32_bf16 v137, v116, s52, v137
    v_dot2_f32_bf16 v138, v117, s51, v138
    v_dot2_f32_bf16 v139, v117, s52, v139
    v_cvt_pk_bf16_f32 v108, v120, v121
    v_cvt_pk_bf16_f32 v109, v122, v123
    v_cvt_pk_bf16_f32 v110, v124, v125
    v_cvt_pk_bf16_f32 v111, v126, v127
    v_cvt_pk_bf16_f32 v112, v128, v129
    v_cvt_pk_bf16_f32 v113, v130, v131
    v_cvt_pk_bf16_f32 v114, v132, v133
    v_cvt_pk_bf16_f32 v115, v134, v135
    v_cvt_pk_bf16_f32 v116, v136, v137
    v_cvt_pk_bf16_f32 v117, v138, v139
    v_permlane16_swap_b32 v108, v110
    v_permlane16_swap_b32 v109, v111
    v_permlane16_swap_b32 v112, v114
    v_permlane16_swap_b32 v113, v115
    buffer_store_dwordx2 v[116:117], v11, s[28:31], s43 offen offset:128
    buffer_store_dwordx4 v[108:111], v9, s[28:31], s43 offen offset:0
    buffer_store_dwordx4 v[112:115], v9, s[28:31], s43 offen offset:64
k3_end:
    s_endpgm
code_end:
    s_endpgm
.section .rodata,"a"
.p2align 6
.amdhsa_kernel front_kernel
  .amdhsa_next_free_vgpr 168
  .amdhsa_next_free_sgpr 80
  .amdhsa_accum_offset 168
  .amdhsa_group_segment_fixed_size 0
  .amdhsa_kernarg_size 112
  .amdhsa_user_sgpr_count 2
  .amdhsa_user_sgpr_kernarg_segment_ptr 1
  .amdhsa_system_sgpr_workgroup_id_x 1
  .amdhsa_float_denorm_mode_32 3
.end_amdhsa_kernel
.p2align 6
.amdhsa_kernel ffn_kernel
  .amdhsa_next_free_vgpr 256
  .amdhsa_next_free_sgpr 80
  .amdhsa_accum_offset 256
  .amdhsa_group_segment_fixed_size 0
  .amdhsa_kernarg_size 112
  .amdhsa_user_sgpr_count 2
  .amdhsa_user_sgpr_kernarg_segment_ptr 1
  .amdhsa_system_sgpr_workgroup_id_x 1
  .amdhsa_float_denorm_mode_32 3
.end_amdhsa_kernel
```
